```python
import torch

def _softmax(x, axis=-1):
    return torch.softmax(x, dim=axis)
def _gelu(x):
    return torch.nn.functional.gelu(x, approximate="tanh")
def _silu(x):
    return torch.nn.functional.silu(x)
def _sigmoid(x):
    return torch.sigmoid(x)
def _layernorm(x, axis=-1, eps=1e-5):
    m = x.mean(dim=axis, keepdim=True)
    v = x.var(dim=axis, keepdim=True, unbiased=False)
    return (x - m) / torch.sqrt(v + eps)
def _scatter_add(tgt, idx, src, axis=0):
    return tgt.clone().index_add_(axis, idx, src)
def _segment_sum(src, seg, n):
    out = torch.zeros((n,) + src.shape[1:], dtype=src.dtype)
    return out.index_add_(0, seg, src)
def _pad(x, pw):
    flat = tuple(v for pair in reversed(pw) for v in pair)
    return torch.nn.functional.pad(x, flat)

kernel_name = 'concat_heads__gqa_block_cached__mha_block_cached__decode'

def setup_inputs():

    _w = (lambda a: (lambda t: t.to(torch.bfloat16) if t.is_floating_point() else t)(torch.as_tensor(a)))
    def _A_setup():
        B, Sq, D = 2, 1, 576
        Hq, Hkv, Sk, Dh = 32, 16, 8192, 128
        assert Hq % Hkv == 0, (Hq, Hkv)
        return {
            "x": _w((lambda *s: torch.randn(*s, dtype=torch.bfloat16) * 0.8)(B, Sq, D)),
            "k_cache": _w((lambda *s: torch.randn(*s, dtype=torch.bfloat16) * 0.8)(B, Hkv, Sk, Dh)),
            "v_cache": _w((lambda *s: torch.randn(*s, dtype=torch.bfloat16) * 0.05)(B, Hkv, Sk, Dh)),
            "wq": _w((lambda *s: torch.randn(*s, dtype=torch.bfloat16) * 0.8)(D, Hq * Dh) * (D ** -0.5)),
            "wo": _w((lambda *s: torch.randn(*s, dtype=torch.bfloat16) * 0.05)(Hq * Dh, D) * ((Hq * Dh) ** -0.5)),
        }
    _A_in = _A_setup()

    def _B_setup():
        B, Sq, D = 2, 1, 576
        H, Sk, Dh = 32, 8192, 128
        return {
            "x": _w((lambda *s: torch.randn(*s, dtype=torch.bfloat16) * 0.8)(B, Sq, D)),
            "k_cache": _w((lambda *s: torch.randn(*s, dtype=torch.bfloat16) * 0.8)(B, H, Sk, Dh)),
            "v_cache": _w((lambda *s: torch.randn(*s, dtype=torch.bfloat16) * 0.05)(B, H, Sk, Dh)),
            "wq": _w((lambda *s: torch.randn(*s, dtype=torch.bfloat16) * 0.8)(D, H * Dh) * (D ** -0.5)),
            "wo": _w((lambda *s: torch.randn(*s, dtype=torch.bfloat16) * 0.05)(H * Dh, D) * ((H * Dh) ** -0.5)),
        }
    _B_in = _B_setup()

    return {
        "A_x": _A_in["x"],
        "A_k_cache": _A_in["k_cache"],
        "A_v_cache": _A_in["v_cache"],
        "A_wq": _A_in["wq"],
        "A_wo": _A_in["wo"],
        "B_x": _B_in["x"],
        "B_k_cache": _B_in["k_cache"],
        "B_v_cache": _B_in["v_cache"],
        "B_wq": _B_in["wq"],
        "B_wo": _B_in["wo"],
    }

def reference(A_x, A_k_cache, A_v_cache, A_wq, A_wo, B_x, B_k_cache, B_v_cache, B_wq, B_wo):
    def _A_ref(x, k_cache, v_cache, wq, wo):
        B, Sq, D = x.shape
        Hq, Dh = 32, 128
        Hkv = k_cache.shape[1]
        rep = Hq // Hkv
        q = (lambda x, *d: x.permute(*d))((x @ wq).reshape(B, Sq, Hq, Dh), 0, 2, 1, 3)
        k = (lambda x, n, axis: torch.repeat_interleave(x, n, dim=axis))(k_cache, rep, axis=1)
        v = (lambda x, n, axis: torch.repeat_interleave(x, n, dim=axis))(v_cache, rep, axis=1)
        scores = torch.einsum("bhqd,bhkd->bhqk", q, k) * (Dh ** -0.5)
        p = _softmax(scores, axis=-1)
        o = torch.einsum("bhqk,bhkd->bhqd", p, v)
        return (lambda x, *d: x.permute(*d))(o, 0, 2, 1, 3).reshape(B, Sq, Hq * Dh) @ wo

    def _B_ref(x, k_cache, v_cache, wq, wo):
        B, Sq, D = x.shape
        H, Dh = 32, 128
        q = (lambda x, *d: x.permute(*d))((x @ wq).reshape(B, Sq, H, Dh), 0, 2, 1, 3)
        scores = torch.einsum("bhqd,bhkd->bhqk", q, k_cache) * (Dh ** -0.5)
        p = _softmax(scores, axis=-1)
        o = torch.einsum("bhqk,bhkd->bhqd", p, v_cache)
        return (lambda x, *d: x.permute(*d))(o, 0, 2, 1, 3).reshape(B, Sq, H * Dh) @ wo

    a = _A_ref(A_x, A_k_cache, A_v_cache, A_wq, A_wo)
    b = _B_ref(B_x, B_k_cache, B_v_cache, B_wq, B_wo)
    return torch.concatenate([a, b], axis=-1)
```

```asm
; @launch grid=(256,1,1) block=(1024,1,1) lds=46208
.amdgcn_target "amdgcn-amd-amdhsa--gfx950"
.text
.globl concat_heads__gqa_block_cached__mha_block_cached__decode_kernel
.p2align 8
.type concat_heads__gqa_block_cached__mha_block_cached__decode_kernel,@function
concat_heads__gqa_block_cached__mha_block_cached__decode_kernel:
    s_cmp_ge_u32 s2, 256
    s_cbranch_scc1 L_end
    s_load_dwordx16 s[36:51], s[0:1], 0
    s_load_dwordx8 s[4:11], s[0:1], 64
    s_load_dwordx2 s[12:13], s[0:1], 96
    v_lshrrev_b32 v2, 6, v0
    v_and_b32 v3, 63, v0
    v_readfirstlane_b32 s28, v2
    v_lshlrev_b32 v1, 4, v3
    s_mov_b32 s31, 0x3e0293ee
    s_lshr_b32 s96, s2, 3
    s_and_b32 s91, s2, 7
    s_lshl_b32 s14, s96, 2
    s_add_u32 s14, s14, s91
    s_lshr_b32 s15, s2, 4
    s_add_u32 s15, s15, 128
    s_and_b32 s33, s2, 15
    s_cmp_eq_u32 s33, 4
    s_cselect_b32 s64, 1, 0
    s_cselect_b32 s14, s15, s14
    s_cmp_lt_u32 s91, 4
    s_cselect_b32 s64, 1, s64
    s_lshr_b32 s33, s14, 3
    s_and_b32 s78, s14, 7
    s_cmp_ge_u32 s33, 9
    s_cselect_b32 s65, 1, 0
    s_mul_i32 s34, s65, 9
    s_sub_u32 s34, s33, s34
    s_lshl_b32 s66, s34, 7
    s_lshl_b32 s79, s33, 13
    s_add_u32 s79, s79, 278528
    s_lshl_b32 s90, s96, 10
    s_mul_i32 s97, s96, 3
    s_mov_b32 s92, 2
    s_mul_i32 s86, s96, 32
    s_waitcnt lgkmcnt(0)
    s_load_dword s69, s[12:13], 262144
    s_mov_b32 s24, s12
    s_and_b32 s25, s13, 0xffff
    s_mov_b32 s26, 0x483000
    s_mov_b32 s27, 0x20000
    s_cmp_lt_u32 s28, 4
    s_cbranch_scc1 L_helper
    s_sub_u32 s29, s28, 4
    s_mul_i32 s93, s29, 1056
    s_add_u32 s93, s93, 8192
    s_and_b32 s39, s39, 0xffff
    s_and_b32 s41, s41, 0xffff
    s_and_b32 s49, s49, 0xffff
    s_and_b32 s51, s51, 0xffff
    s_mov_b32 s94, 0x4000000
    s_mov_b32 s95, 0x8000000
    s_mov_b32 s19, 0x20000
    s_mov_b32 s23, 0x20000
    s_add_u32 s33, s29, 0
    s_lshr_b32 s35, s33, 3
    s_lshl_b32 s35, s35, 3
    s_add_u32 s35, s35, s91
    s_and_b32 s33, s33, 7
    s_lshl_b32 s35, s35, 3
    s_add_u32 s35, s35, s33
    s_lshr_b32 s88, s35, 10
    s_min_u32 s88, s88, 3
    s_add_u32 s33, s35, s86
    s_and_b32 s33, s33, 0x3ff
    s_add_u32 s33, s33, s90
    s_lshr_b32 s35, s35, 11
    s_lshl_b32 s35, s35, 15
    s_add_u32 s35, s35, s33
    s_cmp_eq_u32 s88, 1
    s_cselect_b32 s16, s38, s48
    s_cselect_b32 s17, s39, s49
    s_cselect_b32 s20, s40, s50
    s_cselect_b32 s21, s41, s51
    s_cselect_b32 s18, s94, s95
    s_cselect_b32 s22, s94, s95
    s_lshl_b32 s32, s35, 11
    s_cmp_eq_u32 s88, 3
    s_cselect_b32 s32, s95, s32
    s_waitcnt vmcnt(2)
    buffer_load_dwordx4 v[48:51], v1, s[16:19], s32 offen offset:0 nt
    s_waitcnt vmcnt(2)
    buffer_load_dwordx4 v[52:55], v1, s[16:19], s32 offen offset:1024 nt
    s_waitcnt vmcnt(2)
    buffer_load_dwordx4 v[56:59], v1, s[20:23], s32 offen offset:0 nt
    s_waitcnt vmcnt(2)
    buffer_load_dwordx4 v[60:63], v1, s[20:23], s32 offen offset:1024 nt
    v_and_b32 v2, 15, v3
    v_lshlrev_b32 v2, 4, v2
    v_mov_b32 v3, 0
    s_waitcnt lgkmcnt(0)
    s_barrier
    s_add_u32 s33, s29, 12
    s_lshr_b32 s35, s33, 3
    s_lshl_b32 s35, s35, 3
    s_add_u32 s35, s35, s91
    s_and_b32 s33, s33, 7
    s_lshl_b32 s35, s35, 3
    s_add_u32 s35, s35, s33
    s_lshr_b32 s88, s35, 10
    s_min_u32 s88, s88, 3
    s_add_u32 s33, s35, s86
    s_and_b32 s33, s33, 0x3ff
    s_add_u32 s33, s33, s90
    s_lshr_b32 s35, s35, 11
    s_lshl_b32 s35, s35, 15
    s_add_u32 s35, s35, s33
    s_cmp_eq_u32 s88, 1
    s_cselect_b32 s16, s38, s48
    s_cselect_b32 s17, s39, s49
    s_cselect_b32 s20, s40, s50
    s_cselect_b32 s21, s41, s51
    s_cselect_b32 s18, s94, s95
    s_cselect_b32 s22, s94, s95
    s_lshl_b32 s32, s35, 11
    s_cmp_eq_u32 s88, 3
    s_cselect_b32 s32, s95, s32
    s_waitcnt vmcnt(2)
    buffer_load_dwordx4 v[64:67], v1, s[16:19], s32 offen offset:0 nt
    s_waitcnt vmcnt(2)
    buffer_load_dwordx4 v[68:71], v1, s[16:19], s32 offen offset:1024 nt
    s_waitcnt vmcnt(2)
    buffer_load_dwordx4 v[72:75], v1, s[20:23], s32 offen offset:0 nt
    s_waitcnt vmcnt(2)
    buffer_load_dwordx4 v[76:79], v1, s[20:23], s32 offen offset:1024 nt
    s_add_u32 s33, s29, 24
    s_lshr_b32 s35, s33, 3
    s_lshl_b32 s35, s35, 3
    s_add_u32 s35, s35, s91
    s_and_b32 s33, s33, 7
    s_lshl_b32 s35, s35, 3
    s_add_u32 s35, s35, s33
    s_lshr_b32 s88, s35, 10
    s_min_u32 s88, s88, 3
    s_add_u32 s33, s35, s86
    s_and_b32 s33, s33, 0x3ff
    s_add_u32 s33, s33, s90
    s_lshr_b32 s35, s35, 11
    s_lshl_b32 s35, s35, 15
    s_add_u32 s35, s35, s33
    s_cmp_eq_u32 s88, 1
    s_cselect_b32 s16, s38, s48
    s_cselect_b32 s17, s39, s49
    s_cselect_b32 s20, s40, s50
    s_cselect_b32 s21, s41, s51
    s_cselect_b32 s18, s94, s95
    s_cselect_b32 s22, s94, s95
    s_lshl_b32 s32, s35, 11
    s_cmp_eq_u32 s88, 3
    s_cselect_b32 s32, s95, s32
    s_waitcnt vmcnt(2)
    buffer_load_dwordx4 v[80:83], v1, s[16:19], s32 offen offset:0 nt
    s_waitcnt vmcnt(2)
    buffer_load_dwordx4 v[84:87], v1, s[16:19], s32 offen offset:1024 nt
    s_waitcnt vmcnt(2)
    buffer_load_dwordx4 v[88:91], v1, s[20:23], s32 offen offset:0 nt
    s_waitcnt vmcnt(2)
    buffer_load_dwordx4 v[92:95], v1, s[20:23], s32 offen offset:1024 nt
    s_add_u32 s33, s29, 36
    s_lshr_b32 s35, s33, 3
    s_lshl_b32 s35, s35, 3
    s_add_u32 s35, s35, s91
    s_and_b32 s33, s33, 7
    s_lshl_b32 s35, s35, 3
    s_add_u32 s35, s35, s33
    s_lshr_b32 s88, s35, 10
    s_min_u32 s88, s88, 3
    s_add_u32 s33, s35, s86
    s_and_b32 s33, s33, 0x3ff
    s_add_u32 s33, s33, s90
    s_lshr_b32 s35, s35, 11
    s_lshl_b32 s35, s35, 15
    s_add_u32 s35, s35, s33
    s_cmp_eq_u32 s88, 1
    s_cselect_b32 s16, s38, s48
    s_cselect_b32 s17, s39, s49
    s_cselect_b32 s20, s40, s50
    s_cselect_b32 s21, s41, s51
    s_cselect_b32 s18, s94, s95
    s_cselect_b32 s22, s94, s95
    s_lshl_b32 s32, s35, 11
    s_cmp_eq_u32 s88, 3
    s_cselect_b32 s32, s95, s32
    s_waitcnt vmcnt(2)
    buffer_load_dwordx4 v[96:99], v1, s[16:19], s32 offen offset:0 nt
    s_waitcnt vmcnt(2)
    buffer_load_dwordx4 v[100:103], v1, s[16:19], s32 offen offset:1024 nt
    s_waitcnt vmcnt(2)
    buffer_load_dwordx4 v[104:107], v1, s[20:23], s32 offen offset:0 nt
    s_waitcnt vmcnt(2)
    buffer_load_dwordx4 v[108:111], v1, s[20:23], s32 offen offset:1024 nt
    s_add_u32 s33, s29, 48
    s_lshr_b32 s35, s33, 3
    s_lshl_b32 s35, s35, 3
    s_add_u32 s35, s35, s91
    s_and_b32 s33, s33, 7
    s_lshl_b32 s35, s35, 3
    s_add_u32 s35, s35, s33
    s_lshr_b32 s88, s35, 10
    s_min_u32 s88, s88, 3
    s_add_u32 s33, s35, s86
    s_and_b32 s33, s33, 0x3ff
    s_add_u32 s33, s33, s90
    s_lshr_b32 s35, s35, 11
    s_lshl_b32 s35, s35, 15
    s_add_u32 s35, s35, s33
    s_cmp_eq_u32 s88, 1
    s_cselect_b32 s16, s38, s48
    s_cselect_b32 s17, s39, s49
    s_cselect_b32 s20, s40, s50
    s_cselect_b32 s21, s41, s51
    s_cselect_b32 s18, s94, s95
    s_cselect_b32 s22, s94, s95
    s_lshl_b32 s32, s35, 11
    s_cmp_eq_u32 s88, 3
    s_cselect_b32 s32, s95, s32
    s_waitcnt vmcnt(2)
    buffer_load_dwordx4 v[112:115], v1, s[16:19], s32 offen offset:0 nt
    s_waitcnt vmcnt(2)
    buffer_load_dwordx4 v[116:119], v1, s[16:19], s32 offen offset:1024 nt
    s_waitcnt vmcnt(2)
    buffer_load_dwordx4 v[120:123], v1, s[20:23], s32 offen offset:0 nt
    s_waitcnt vmcnt(2)
    buffer_load_dwordx4 v[124:127], v1, s[20:23], s32 offen offset:1024 nt
    v_mov_b32 v12, 0
    v_mov_b32 v13, 0
    v_mov_b32 v14, 0
    v_mov_b32 v15, 0
    v_mov_b32 v16, 0
    v_mov_b32 v17, 0
    v_mov_b32 v18, 0
    v_mov_b32 v19, 0
    v_mov_b32 v20, 0
    v_mov_b32 v21, 0
    v_mov_b32 v22, 0
    v_mov_b32 v23, 0
    v_mov_b32 v24, 0
    v_mov_b32 v25, 0
    v_mov_b32 v26, 0
    v_mov_b32 v27, 0
    v_mov_b32 v30, 0xff7fffff
    v_mov_b32 v28, 0
    v_mov_b32 v31, 0xff7fffff
    v_mov_b32 v29, 0
    s_add_u32 s69, s69, 1
    s_mov_b32 s30, 0
    s_mov_b32 s87, 0
L_q0wait:
    ds_read_b32 v46, v3 offset:32
    s_add_u32 s87, s87, 1
    s_waitcnt lgkmcnt(0)
    v_readfirstlane_b32 s33, v46
    s_nop 0
    s_cmp_lg_u32 s33, 0
    s_cbranch_scc1 L_q0ok
    s_sleep 1
    s_cmp_lt_u32 s87, 4000000
    s_cbranch_scc1 L_q0wait
L_q0ok:
    ds_read_b128 v[4:7], v2 offset:1280
    ds_read_b128 v[8:11], v2 offset:1536
    s_waitcnt lgkmcnt(0)
    s_waitcnt vmcnt(18)
    v_mov_b32 v47, 1
    s_mov_b64 exec, 1
    ds_add_rtn_u32 v46, v3, v47 offset:4
    s_mov_b64 exec, -1
    v_dot2_f32_bf16 v34, v48, v4, 0
    v_dot2_f32_bf16 v35, v52, v4, 0
    v_dot2_f32_bf16 v34, v49, v5, v34
    v_dot2_f32_bf16 v35, v53, v5, v35
    v_dot2_f32_bf16 v34, v50, v6, v34
    v_dot2_f32_bf16 v35, v54, v6, v35
    v_dot2_f32_bf16 v34, v51, v7, v34
    v_dot2_f32_bf16 v35, v55, v7, v35
    s_mov_b32 s87, 0
    s_waitcnt lgkmcnt(0)
    v_readfirstlane_b32 s33, v46
    s_nop 0
    s_lshr_b32 s34, s33, 3
    s_lshl_b32 s34, s34, 2
    v_mov_b32 v46, s34
    ds_read_b32 v47, v46 offset:256
    v_add_f32_dpp v34, v34, v34 row_ror:8 row_mask:0xf bank_mask:0xf
    v_add_f32_dpp v35, v35, v35 row_ror:8 row_mask:0xf bank_mask:0xf
    s_nop 0
    v_add_f32_dpp v34, v34, v34 row_ror:4 row_mask:0xf bank_mask:0xf
    v_add_f32_dpp v35, v35, v35 row_ror:4 row_mask:0xf bank_mask:0xf
    s_nop 0
    v_add_f32_dpp v34, v34, v34 row_ror:2 row_mask:0xf bank_mask:0xf
    v_add_f32_dpp v35, v35, v35 row_ror:2 row_mask:0xf bank_mask:0xf
    s_nop 0
    v_add_f32_dpp v34, v34, v34 row_ror:1 row_mask:0xf bank_mask:0xf
    v_add_f32_dpp v35, v35, v35 row_ror:1 row_mask:0xf bank_mask:0xf
    v_mul_f32 v34, s31, v34
    v_mul_f32 v35, s31, v35
    v_max3_f32 v38, v30, v34, v35
    v_sub_f32 v32, v30, v38
    v_sub_f32 v34, v34, v38
    v_sub_f32 v35, v35, v38
    v_exp_f32 v32, v32
    v_exp_f32 v34, v34
    v_exp_f32 v35, v35
L_lk1:
    s_add_u32 s87, s87, 1
    s_waitcnt lgkmcnt(0)
    v_readfirstlane_b32 s35, v47
    s_nop 0
    s_cmp_lg_u32 s35, -1
    s_cbranch_scc1 L_lk2
    s_sleep 1
    ds_read_b32 v47, v46 offset:256
    s_cmp_lt_u32 s87, 1000000
    s_cbranch_scc1 L_lk1
    s_waitcnt lgkmcnt(0)
    s_mov_b32 s35, 400
L_lk2:
    s_and_b32 s33, s33, 7
    s_lshl_b32 s35, s35, 3
    s_add_u32 s35, s35, s33
    s_lshr_b32 s88, s35, 10
    s_min_u32 s88, s88, 3
    s_add_u32 s33, s35, s86
    s_and_b32 s33, s33, 0x3ff
    s_add_u32 s33, s33, s90
    s_lshr_b32 s35, s35, 11
    s_lshl_b32 s35, s35, 15
    s_add_u32 s35, s35, s33
    s_cmp_eq_u32 s88, 1
    s_cselect_b32 s16, s38, s48
    s_cselect_b32 s17, s39, s49
    s_cselect_b32 s20, s40, s50
    s_cselect_b32 s21, s41, s51
    s_cselect_b32 s18, s94, s95
    s_cselect_b32 s22, s94, s95
    s_lshl_b32 s32, s35, 11
    s_cmp_eq_u32 s88, 3
    s_cselect_b32 s32, s95, s32
    buffer_load_dwordx4 v[48:51], v1, s[16:19], s32 offen offset:0 nt
    buffer_load_dwordx4 v[52:55], v1, s[16:19], s32 offen offset:1024 nt
    v_mov_b32 v30, v38
    v_pk_mul_f32 v[12:13], v[12:13], v[32:33] op_sel:[0,0] op_sel_hi:[1,0]
    v_pk_mul_f32 v[14:15], v[14:15], v[32:33] op_sel:[0,0] op_sel_hi:[1,0]
    v_pk_mul_f32 v[16:17], v[16:17], v[32:33] op_sel:[0,0] op_sel_hi:[1,0]
    v_pk_mul_f32 v[18:19], v[18:19], v[32:33] op_sel:[0,0] op_sel_hi:[1,0]
    v_fma_f32 v28, v28, v32, v34
    v_add_f32 v28, v28, v35
    s_waitcnt vmcnt(18)
    v_lshlrev_b32 v38, 16, v56
    v_and_b32 v39, 0xffff0000, v56
    v_lshlrev_b32 v40, 16, v57
    v_and_b32 v41, 0xffff0000, v57
    v_lshlrev_b32 v42, 16, v58
    v_and_b32 v43, 0xffff0000, v58
    v_lshlrev_b32 v44, 16, v59
    v_and_b32 v45, 0xffff0000, v59
    v_pk_fma_f32 v[12:13], v[38:39], v[34:35], v[12:13] op_sel:[0,0,0] op_sel_hi:[1,0,1]
    v_pk_fma_f32 v[14:15], v[40:41], v[34:35], v[14:15] op_sel:[0,0,0] op_sel_hi:[1,0,1]
    v_pk_fma_f32 v[16:17], v[42:43], v[34:35], v[16:17] op_sel:[0,0,0] op_sel_hi:[1,0,1]
    v_pk_fma_f32 v[18:19], v[44:45], v[34:35], v[18:19] op_sel:[0,0,0] op_sel_hi:[1,0,1]
    v_lshlrev_b32 v38, 16, v60
    v_and_b32 v39, 0xffff0000, v60
    v_lshlrev_b32 v40, 16, v61
    v_and_b32 v41, 0xffff0000, v61
    v_lshlrev_b32 v42, 16, v62
    v_and_b32 v43, 0xffff0000, v62
    v_lshlrev_b32 v44, 16, v63
    v_and_b32 v45, 0xffff0000, v63
    v_pk_fma_f32 v[12:13], v[38:39], v[34:35], v[12:13] op_sel:[0,1,0] op_sel_hi:[1,1,1]
    v_pk_fma_f32 v[14:15], v[40:41], v[34:35], v[14:15] op_sel:[0,1,0] op_sel_hi:[1,1,1]
    v_pk_fma_f32 v[16:17], v[42:43], v[34:35], v[16:17] op_sel:[0,1,0] op_sel_hi:[1,1,1]
    v_pk_fma_f32 v[18:19], v[44:45], v[34:35], v[18:19] op_sel:[0,1,0] op_sel_hi:[1,1,1]
    buffer_load_dwordx4 v[56:59], v1, s[20:23], s32 offen offset:0 nt
    buffer_load_dwordx4 v[60:63], v1, s[20:23], s32 offen offset:1024 nt
    s_waitcnt vmcnt(18)
    v_dot2_f32_bf16 v34, v64, v4, 0
    v_dot2_f32_bf16 v35, v68, v4, 0
    v_dot2_f32_bf16 v34, v65, v5, v34
    v_dot2_f32_bf16 v35, v69, v5, v35
    v_dot2_f32_bf16 v34, v66, v6, v34
    v_dot2_f32_bf16 v35, v70, v6, v35
    v_dot2_f32_bf16 v34, v67, v7, v34
    v_dot2_f32_bf16 v35, v71, v7, v35
    s_nop 1
    v_add_f32_dpp v34, v34, v34 row_ror:8 row_mask:0xf bank_mask:0xf
    v_add_f32_dpp v35, v35, v35 row_ror:8 row_mask:0xf bank_mask:0xf
    s_nop 0
    v_add_f32_dpp v34, v34, v34 row_ror:4 row_mask:0xf bank_mask:0xf
    v_add_f32_dpp v35, v35, v35 row_ror:4 row_mask:0xf bank_mask:0xf
    s_nop 0
    v_add_f32_dpp v34, v34, v34 row_ror:2 row_mask:0xf bank_mask:0xf
    v_add_f32_dpp v35, v35, v35 row_ror:2 row_mask:0xf bank_mask:0xf
    s_nop 0
    v_add_f32_dpp v34, v34, v34 row_ror:1 row_mask:0xf bank_mask:0xf
    v_add_f32_dpp v35, v35, v35 row_ror:1 row_mask:0xf bank_mask:0xf
    v_mul_f32 v34, s31, v34
    v_mul_f32 v35, s31, v35
    v_max3_f32 v38, v30, v34, v35
    v_sub_f32 v32, v30, v38
    v_sub_f32 v34, v34, v38
    v_sub_f32 v35, v35, v38
    v_exp_f32 v32, v32
    v_exp_f32 v34, v34
    v_exp_f32 v35, v35
    v_mov_b32 v30, v38
    v_pk_mul_f32 v[12:13], v[12:13], v[32:33] op_sel:[0,0] op_sel_hi:[1,0]
    v_pk_mul_f32 v[14:15], v[14:15], v[32:33] op_sel:[0,0] op_sel_hi:[1,0]
    v_pk_mul_f32 v[16:17], v[16:17], v[32:33] op_sel:[0,0] op_sel_hi:[1,0]
    v_pk_mul_f32 v[18:19], v[18:19], v[32:33] op_sel:[0,0] op_sel_hi:[1,0]
    v_fma_f32 v28, v28, v32, v34
    v_add_f32 v28, v28, v35
    s_waitcnt vmcnt(16)
    v_lshlrev_b32 v38, 16, v72
    v_and_b32 v39, 0xffff0000, v72
    v_lshlrev_b32 v40, 16, v73
    v_and_b32 v41, 0xffff0000, v73
    v_lshlrev_b32 v42, 16, v74
    v_and_b32 v43, 0xffff0000, v74
    v_lshlrev_b32 v44, 16, v75
    v_and_b32 v45, 0xffff0000, v75
    v_pk_fma_f32 v[12:13], v[38:39], v[34:35], v[12:13] op_sel:[0,0,0] op_sel_hi:[1,0,1]
    v_pk_fma_f32 v[14:15], v[40:41], v[34:35], v[14:15] op_sel:[0,0,0] op_sel_hi:[1,0,1]
    v_pk_fma_f32 v[16:17], v[42:43], v[34:35], v[16:17] op_sel:[0,0,0] op_sel_hi:[1,0,1]
    v_pk_fma_f32 v[18:19], v[44:45], v[34:35], v[18:19] op_sel:[0,0,0] op_sel_hi:[1,0,1]
    v_lshlrev_b32 v38, 16, v76
    v_and_b32 v39, 0xffff0000, v76
    v_lshlrev_b32 v40, 16, v77
    v_and_b32 v41, 0xffff0000, v77
    v_lshlrev_b32 v42, 16, v78
    v_and_b32 v43, 0xffff0000, v78
    v_lshlrev_b32 v44, 16, v79
    v_and_b32 v45, 0xffff0000, v79
    v_pk_fma_f32 v[12:13], v[38:39], v[34:35], v[12:13] op_sel:[0,1,0] op_sel_hi:[1,1,1]
    v_pk_fma_f32 v[14:15], v[40:41], v[34:35], v[14:15] op_sel:[0,1,0] op_sel_hi:[1,1,1]
    v_pk_fma_f32 v[16:17], v[42:43], v[34:35], v[16:17] op_sel:[0,1,0] op_sel_hi:[1,1,1]
    v_pk_fma_f32 v[18:19], v[44:45], v[34:35], v[18:19] op_sel:[0,1,0] op_sel_hi:[1,1,1]
    s_waitcnt vmcnt(14)
    v_dot2_f32_bf16 v34, v80, v4, 0
    v_dot2_f32_bf16 v35, v84, v4, 0
    v_dot2_f32_bf16 v34, v81, v5, v34
    v_dot2_f32_bf16 v35, v85, v5, v35
    v_dot2_f32_bf16 v34, v82, v6, v34
    v_dot2_f32_bf16 v35, v86, v6, v35
    v_dot2_f32_bf16 v34, v83, v7, v34
    v_dot2_f32_bf16 v35, v87, v7, v35
    s_nop 1
    v_add_f32_dpp v34, v34, v34 row_ror:8 row_mask:0xf bank_mask:0xf
    v_add_f32_dpp v35, v35, v35 row_ror:8 row_mask:0xf bank_mask:0xf
    s_nop 0
    v_add_f32_dpp v34, v34, v34 row_ror:4 row_mask:0xf bank_mask:0xf
    v_add_f32_dpp v35, v35, v35 row_ror:4 row_mask:0xf bank_mask:0xf
    s_nop 0
    v_add_f32_dpp v34, v34, v34 row_ror:2 row_mask:0xf bank_mask:0xf
    v_add_f32_dpp v35, v35, v35 row_ror:2 row_mask:0xf bank_mask:0xf
    s_nop 0
    v_add_f32_dpp v34, v34, v34 row_ror:1 row_mask:0xf bank_mask:0xf
    v_add_f32_dpp v35, v35, v35 row_ror:1 row_mask:0xf bank_mask:0xf
    v_mul_f32 v34, s31, v34
    v_mul_f32 v35, s31, v35
    v_max3_f32 v38, v30, v34, v35
    v_sub_f32 v32, v30, v38
    v_sub_f32 v34, v34, v38
    v_sub_f32 v35, v35, v38
    v_exp_f32 v32, v32
    v_exp_f32 v34, v34
    v_exp_f32 v35, v35
    v_mov_b32 v30, v38
    v_pk_mul_f32 v[12:13], v[12:13], v[32:33] op_sel:[0,0] op_sel_hi:[1,0]
    v_pk_mul_f32 v[14:15], v[14:15], v[32:33] op_sel:[0,0] op_sel_hi:[1,0]
    v_pk_mul_f32 v[16:17], v[16:17], v[32:33] op_sel:[0,0] op_sel_hi:[1,0]
    v_pk_mul_f32 v[18:19], v[18:19], v[32:33] op_sel:[0,0] op_sel_hi:[1,0]
    v_fma_f32 v28, v28, v32, v34
    v_add_f32 v28, v28, v35
    s_waitcnt vmcnt(12)
    v_lshlrev_b32 v38, 16, v88
    v_and_b32 v39, 0xffff0000, v88
    v_lshlrev_b32 v40, 16, v89
    v_and_b32 v41, 0xffff0000, v89
    v_lshlrev_b32 v42, 16, v90
    v_and_b32 v43, 0xffff0000, v90
    v_lshlrev_b32 v44, 16, v91
    v_and_b32 v45, 0xffff0000, v91
    v_pk_fma_f32 v[12:13], v[38:39], v[34:35], v[12:13] op_sel:[0,0,0] op_sel_hi:[1,0,1]
    v_pk_fma_f32 v[14:15], v[40:41], v[34:35], v[14:15] op_sel:[0,0,0] op_sel_hi:[1,0,1]
    v_pk_fma_f32 v[16:17], v[42:43], v[34:35], v[16:17] op_sel:[0,0,0] op_sel_hi:[1,0,1]
    v_pk_fma_f32 v[18:19], v[44:45], v[34:35], v[18:19] op_sel:[0,0,0] op_sel_hi:[1,0,1]
    v_lshlrev_b32 v38, 16, v92
    v_and_b32 v39, 0xffff0000, v92
    v_lshlrev_b32 v40, 16, v93
    v_and_b32 v41, 0xffff0000, v93
    v_lshlrev_b32 v42, 16, v94
    v_and_b32 v43, 0xffff0000, v94
    v_lshlrev_b32 v44, 16, v95
    v_and_b32 v45, 0xffff0000, v95
    v_pk_fma_f32 v[12:13], v[38:39], v[34:35], v[12:13] op_sel:[0,1,0] op_sel_hi:[1,1,1]
    v_pk_fma_f32 v[14:15], v[40:41], v[34:35], v[14:15] op_sel:[0,1,0] op_sel_hi:[1,1,1]
    v_pk_fma_f32 v[16:17], v[42:43], v[34:35], v[16:17] op_sel:[0,1,0] op_sel_hi:[1,1,1]
    v_pk_fma_f32 v[18:19], v[44:45], v[34:35], v[18:19] op_sel:[0,1,0] op_sel_hi:[1,1,1]
    s_waitcnt vmcnt(10)
    v_dot2_f32_bf16 v34, v96, v4, 0
    v_dot2_f32_bf16 v35, v100, v4, 0
    v_dot2_f32_bf16 v34, v97, v5, v34
    v_dot2_f32_bf16 v35, v101, v5, v35
    v_dot2_f32_bf16 v34, v98, v6, v34
    v_dot2_f32_bf16 v35, v102, v6, v35
    v_dot2_f32_bf16 v34, v99, v7, v34
    v_dot2_f32_bf16 v35, v103, v7, v35
    s_nop 1
    v_add_f32_dpp v34, v34, v34 row_ror:8 row_mask:0xf bank_mask:0xf
    v_add_f32_dpp v35, v35, v35 row_ror:8 row_mask:0xf bank_mask:0xf
    s_nop 0
    v_add_f32_dpp v34, v34, v34 row_ror:4 row_mask:0xf bank_mask:0xf
    v_add_f32_dpp v35, v35, v35 row_ror:4 row_mask:0xf bank_mask:0xf
    s_nop 0
    v_add_f32_dpp v34, v34, v34 row_ror:2 row_mask:0xf bank_mask:0xf
    v_add_f32_dpp v35, v35, v35 row_ror:2 row_mask:0xf bank_mask:0xf
    s_nop 0
    v_add_f32_dpp v34, v34, v34 row_ror:1 row_mask:0xf bank_mask:0xf
    v_add_f32_dpp v35, v35, v35 row_ror:1 row_mask:0xf bank_mask:0xf
    v_mul_f32 v34, s31, v34
    v_mul_f32 v35, s31, v35
    v_max3_f32 v38, v30, v34, v35
    v_sub_f32 v32, v30, v38
    v_sub_f32 v34, v34, v38
    v_sub_f32 v35, v35, v38
    v_exp_f32 v32, v32
    v_exp_f32 v34, v34
    v_exp_f32 v35, v35
    v_mov_b32 v30, v38
    v_pk_mul_f32 v[12:13], v[12:13], v[32:33] op_sel:[0,0] op_sel_hi:[1,0]
    v_pk_mul_f32 v[14:15], v[14:15], v[32:33] op_sel:[0,0] op_sel_hi:[1,0]
    v_pk_mul_f32 v[16:17], v[16:17], v[32:33] op_sel:[0,0] op_sel_hi:[1,0]
    v_pk_mul_f32 v[18:19], v[18:19], v[32:33] op_sel:[0,0] op_sel_hi:[1,0]
    v_fma_f32 v28, v28, v32, v34
    v_add_f32 v28, v28, v35
    s_waitcnt vmcnt(8)
    v_lshlrev_b32 v38, 16, v104
    v_and_b32 v39, 0xffff0000, v104
    v_lshlrev_b32 v40, 16, v105
    v_and_b32 v41, 0xffff0000, v105
    v_lshlrev_b32 v42, 16, v106
    v_and_b32 v43, 0xffff0000, v106
    v_lshlrev_b32 v44, 16, v107
    v_and_b32 v45, 0xffff0000, v107
    v_pk_fma_f32 v[12:13], v[38:39], v[34:35], v[12:13] op_sel:[0,0,0] op_sel_hi:[1,0,1]
    v_pk_fma_f32 v[14:15], v[40:41], v[34:35], v[14:15] op_sel:[0,0,0] op_sel_hi:[1,0,1]
    v_pk_fma_f32 v[16:17], v[42:43], v[34:35], v[16:17] op_sel:[0,0,0] op_sel_hi:[1,0,1]
    v_pk_fma_f32 v[18:19], v[44:45], v[34:35], v[18:19] op_sel:[0,0,0] op_sel_hi:[1,0,1]
    v_lshlrev_b32 v38, 16, v108
    v_and_b32 v39, 0xffff0000, v108
    v_lshlrev_b32 v40, 16, v109
    v_and_b32 v41, 0xffff0000, v109
    v_lshlrev_b32 v42, 16, v110
    v_and_b32 v43, 0xffff0000, v110
    v_lshlrev_b32 v44, 16, v111
    v_and_b32 v45, 0xffff0000, v111
    v_pk_fma_f32 v[12:13], v[38:39], v[34:35], v[12:13] op_sel:[0,1,0] op_sel_hi:[1,1,1]
    v_pk_fma_f32 v[14:15], v[40:41], v[34:35], v[14:15] op_sel:[0,1,0] op_sel_hi:[1,1,1]
    v_pk_fma_f32 v[16:17], v[42:43], v[34:35], v[16:17] op_sel:[0,1,0] op_sel_hi:[1,1,1]
    v_pk_fma_f32 v[18:19], v[44:45], v[34:35], v[18:19] op_sel:[0,1,0] op_sel_hi:[1,1,1]
    s_waitcnt vmcnt(6)
    v_dot2_f32_bf16 v34, v112, v4, 0
    v_dot2_f32_bf16 v35, v116, v4, 0
    v_dot2_f32_bf16 v34, v113, v5, v34
    v_dot2_f32_bf16 v35, v117, v5, v35
    v_dot2_f32_bf16 v34, v114, v6, v34
    v_dot2_f32_bf16 v35, v118, v6, v35
    v_dot2_f32_bf16 v34, v115, v7, v34
    v_dot2_f32_bf16 v35, v119, v7, v35
    s_nop 1
    v_add_f32_dpp v34, v34, v34 row_ror:8 row_mask:0xf bank_mask:0xf
    v_add_f32_dpp v35, v35, v35 row_ror:8 row_mask:0xf bank_mask:0xf
    s_nop 0
    v_add_f32_dpp v34, v34, v34 row_ror:4 row_mask:0xf bank_mask:0xf
    v_add_f32_dpp v35, v35, v35 row_ror:4 row_mask:0xf bank_mask:0xf
    s_nop 0
    v_add_f32_dpp v34, v34, v34 row_ror:2 row_mask:0xf bank_mask:0xf
    v_add_f32_dpp v35, v35, v35 row_ror:2 row_mask:0xf bank_mask:0xf
    s_nop 0
    v_add_f32_dpp v34, v34, v34 row_ror:1 row_mask:0xf bank_mask:0xf
    v_add_f32_dpp v35, v35, v35 row_ror:1 row_mask:0xf bank_mask:0xf
    v_mul_f32 v34, s31, v34
    v_mul_f32 v35, s31, v35
    v_max3_f32 v38, v30, v34, v35
    v_sub_f32 v32, v30, v38
    v_sub_f32 v34, v34, v38
    v_sub_f32 v35, v35, v38
    v_exp_f32 v32, v32
    v_exp_f32 v34, v34
    v_exp_f32 v35, v35
    v_mov_b32 v30, v38
    v_pk_mul_f32 v[12:13], v[12:13], v[32:33] op_sel:[0,0] op_sel_hi:[1,0]
    v_pk_mul_f32 v[14:15], v[14:15], v[32:33] op_sel:[0,0] op_sel_hi:[1,0]
    v_pk_mul_f32 v[16:17], v[16:17], v[32:33] op_sel:[0,0] op_sel_hi:[1,0]
    v_pk_mul_f32 v[18:19], v[18:19], v[32:33] op_sel:[0,0] op_sel_hi:[1,0]
    v_fma_f32 v28, v28, v32, v34
    v_add_f32 v28, v28, v35
    s_waitcnt vmcnt(4)
    v_lshlrev_b32 v38, 16, v120
    v_and_b32 v39, 0xffff0000, v120
    v_lshlrev_b32 v40, 16, v121
    v_and_b32 v41, 0xffff0000, v121
    v_lshlrev_b32 v42, 16, v122
    v_and_b32 v43, 0xffff0000, v122
    v_lshlrev_b32 v44, 16, v123
    v_and_b32 v45, 0xffff0000, v123
    v_pk_fma_f32 v[12:13], v[38:39], v[34:35], v[12:13] op_sel:[0,0,0] op_sel_hi:[1,0,1]
    v_pk_fma_f32 v[14:15], v[40:41], v[34:35], v[14:15] op_sel:[0,0,0] op_sel_hi:[1,0,1]
    v_pk_fma_f32 v[16:17], v[42:43], v[34:35], v[16:17] op_sel:[0,0,0] op_sel_hi:[1,0,1]
    v_pk_fma_f32 v[18:19], v[44:45], v[34:35], v[18:19] op_sel:[0,0,0] op_sel_hi:[1,0,1]
    v_lshlrev_b32 v38, 16, v124
    v_and_b32 v39, 0xffff0000, v124
    v_lshlrev_b32 v40, 16, v125
    v_and_b32 v41, 0xffff0000, v125
    v_lshlrev_b32 v42, 16, v126
    v_and_b32 v43, 0xffff0000, v126
    v_lshlrev_b32 v44, 16, v127
    v_and_b32 v45, 0xffff0000, v127
    v_pk_fma_f32 v[12:13], v[38:39], v[34:35], v[12:13] op_sel:[0,1,0] op_sel_hi:[1,1,1]
    v_pk_fma_f32 v[14:15], v[40:41], v[34:35], v[14:15] op_sel:[0,1,0] op_sel_hi:[1,1,1]
    v_pk_fma_f32 v[16:17], v[42:43], v[34:35], v[16:17] op_sel:[0,1,0] op_sel_hi:[1,1,1]
    v_pk_fma_f32 v[18:19], v[44:45], v[34:35], v[18:19] op_sel:[0,1,0] op_sel_hi:[1,1,1]
L_nextB0:
    s_mov_b32 s89, s88
    s_mov_b32 s3, 0
    s_cmp_eq_u32 s89, 3
    s_cbranch_scc1 L_flush
    s_cmp_lg_u32 s89, s30
    s_cbranch_scc1 L_flush
L_stepB0:
    s_waitcnt vmcnt(2)
    v_mov_b32 v47, 1
    s_mov_b64 exec, 1
    ds_add_rtn_u32 v46, v3, v47 offset:4
    s_mov_b64 exec, -1
    v_dot2_f32_bf16 v34, v48, v4, 0
    v_dot2_f32_bf16 v35, v52, v4, 0
    v_dot2_f32_bf16 v34, v49, v5, v34
    v_dot2_f32_bf16 v35, v53, v5, v35
    v_dot2_f32_bf16 v34, v50, v6, v34
    v_dot2_f32_bf16 v35, v54, v6, v35
    v_dot2_f32_bf16 v34, v51, v7, v34
    v_dot2_f32_bf16 v35, v55, v7, v35
    s_mov_b32 s87, 0
    s_waitcnt lgkmcnt(0)
    v_readfirstlane_b32 s33, v46
    s_nop 0
    s_lshr_b32 s34, s33, 3
    s_lshl_b32 s34, s34, 2
    v_mov_b32 v46, s34
    ds_read_b32 v47, v46 offset:256
    v_add_f32_dpp v34, v34, v34 row_ror:8 row_mask:0xf bank_mask:0xf
    v_add_f32_dpp v35, v35, v35 row_ror:8 row_mask:0xf bank_mask:0xf
    s_nop 0
    v_add_f32_dpp v34, v34, v34 row_ror:4 row_mask:0xf bank_mask:0xf
    v_add_f32_dpp v35, v35, v35 row_ror:4 row_mask:0xf bank_mask:0xf
    s_nop 0
    v_add_f32_dpp v34, v34, v34 row_ror:2 row_mask:0xf bank_mask:0xf
    v_add_f32_dpp v35, v35, v35 row_ror:2 row_mask:0xf bank_mask:0xf
    s_nop 0
    v_add_f32_dpp v34, v34, v34 row_ror:1 row_mask:0xf bank_mask:0xf
    v_add_f32_dpp v35, v35, v35 row_ror:1 row_mask:0xf bank_mask:0xf
    v_mul_f32 v34, s31, v34
    v_mul_f32 v35, s31, v35
    v_max3_f32 v38, v30, v34, v35
    v_sub_f32 v32, v30, v38
    v_sub_f32 v34, v34, v38
    v_sub_f32 v35, v35, v38
    v_exp_f32 v32, v32
    v_exp_f32 v34, v34
    v_exp_f32 v35, v35
L_lk3:
    s_add_u32 s87, s87, 1
    s_waitcnt lgkmcnt(0)
    v_readfirstlane_b32 s35, v47
    s_nop 0
    s_cmp_lg_u32 s35, -1
    s_cbranch_scc1 L_lk4
    s_sleep 1
    ds_read_b32 v47, v46 offset:256
    s_cmp_lt_u32 s87, 1000000
    s_cbranch_scc1 L_lk3
    s_waitcnt lgkmcnt(0)
    s_mov_b32 s35, 400
L_lk4:
    s_and_b32 s33, s33, 7
    s_lshl_b32 s35, s35, 3
    s_add_u32 s35, s35, s33
    s_lshr_b32 s88, s35, 10
    s_min_u32 s88, s88, 3
    s_add_u32 s33, s35, s86
    s_and_b32 s33, s33, 0x3ff
    s_add_u32 s33, s33, s90
    s_lshr_b32 s35, s35, 11
    s_lshl_b32 s35, s35, 15
    s_add_u32 s35, s35, s33
    s_cmp_eq_u32 s88, 1
    s_cselect_b32 s16, s38, s48
    s_cselect_b32 s17, s39, s49
    s_cselect_b32 s20, s40, s50
    s_cselect_b32 s21, s41, s51
    s_cselect_b32 s18, s94, s95
    s_cselect_b32 s22, s94, s95
    s_lshl_b32 s32, s35, 11
    s_cmp_eq_u32 s88, 3
    s_cselect_b32 s32, s95, s32
    buffer_load_dwordx4 v[48:51], v1, s[16:19], s32 offen offset:0 nt
    buffer_load_dwordx4 v[52:55], v1, s[16:19], s32 offen offset:1024 nt
    v_mov_b32 v30, v38
    v_pk_mul_f32 v[12:13], v[12:13], v[32:33] op_sel:[0,0] op_sel_hi:[1,0]
    v_pk_mul_f32 v[14:15], v[14:15], v[32:33] op_sel:[0,0] op_sel_hi:[1,0]
    v_pk_mul_f32 v[16:17], v[16:17], v[32:33] op_sel:[0,0] op_sel_hi:[1,0]
    v_pk_mul_f32 v[18:19], v[18:19], v[32:33] op_sel:[0,0] op_sel_hi:[1,0]
    v_fma_f32 v28, v28, v32, v34
    v_add_f32 v28, v28, v35
    s_waitcnt vmcnt(2)
    v_lshlrev_b32 v38, 16, v56
    v_and_b32 v39, 0xffff0000, v56
    v_lshlrev_b32 v40, 16, v57
    v_and_b32 v41, 0xffff0000, v57
    v_lshlrev_b32 v42, 16, v58
    v_and_b32 v43, 0xffff0000, v58
    v_lshlrev_b32 v44, 16, v59
    v_and_b32 v45, 0xffff0000, v59
    v_pk_fma_f32 v[12:13], v[38:39], v[34:35], v[12:13] op_sel:[0,0,0] op_sel_hi:[1,0,1]
    v_pk_fma_f32 v[14:15], v[40:41], v[34:35], v[14:15] op_sel:[0,0,0] op_sel_hi:[1,0,1]
    v_pk_fma_f32 v[16:17], v[42:43], v[34:35], v[16:17] op_sel:[0,0,0] op_sel_hi:[1,0,1]
    v_pk_fma_f32 v[18:19], v[44:45], v[34:35], v[18:19] op_sel:[0,0,0] op_sel_hi:[1,0,1]
    v_lshlrev_b32 v38, 16, v60
    v_and_b32 v39, 0xffff0000, v60
    v_lshlrev_b32 v40, 16, v61
    v_and_b32 v41, 0xffff0000, v61
    v_lshlrev_b32 v42, 16, v62
    v_and_b32 v43, 0xffff0000, v62
    v_lshlrev_b32 v44, 16, v63
    v_and_b32 v45, 0xffff0000, v63
    v_pk_fma_f32 v[12:13], v[38:39], v[34:35], v[12:13] op_sel:[0,1,0] op_sel_hi:[1,1,1]
    v_pk_fma_f32 v[14:15], v[40:41], v[34:35], v[14:15] op_sel:[0,1,0] op_sel_hi:[1,1,1]
    v_pk_fma_f32 v[16:17], v[42:43], v[34:35], v[16:17] op_sel:[0,1,0] op_sel_hi:[1,1,1]
    v_pk_fma_f32 v[18:19], v[44:45], v[34:35], v[18:19] op_sel:[0,1,0] op_sel_hi:[1,1,1]
    buffer_load_dwordx4 v[56:59], v1, s[20:23], s32 offen offset:0 nt
    buffer_load_dwordx4 v[60:63], v1, s[20:23], s32 offen offset:1024 nt
    s_branch L_nextB0
L_nextA0:
    s_mov_b32 s89, s88
    s_mov_b32 s3, 0
    s_cmp_eq_u32 s89, 3
    s_cbranch_scc1 L_flush
    s_cmp_lg_u32 s89, s30
    s_cbranch_scc1 L_flush
L_stepA0:
    s_waitcnt vmcnt(2)
    v_mov_b32 v47, 1
    s_mov_b64 exec, 1
    ds_add_rtn_u32 v46, v3, v47 offset:4
    s_mov_b64 exec, -1
    v_dot2_f32_bf16 v34, v48, v4, 0
    v_dot2_f32_bf16 v36, v48, v8, 0
    v_dot2_f32_bf16 v35, v52, v4, 0
    v_dot2_f32_bf16 v37, v52, v8, 0
    v_dot2_f32_bf16 v34, v49, v5, v34
    v_dot2_f32_bf16 v36, v49, v9, v36
    v_dot2_f32_bf16 v35, v53, v5, v35
    v_dot2_f32_bf16 v37, v53, v9, v37
    v_dot2_f32_bf16 v34, v50, v6, v34
    v_dot2_f32_bf16 v36, v50, v10, v36
    v_dot2_f32_bf16 v35, v54, v6, v35
    v_dot2_f32_bf16 v37, v54, v10, v37
    v_dot2_f32_bf16 v34, v51, v7, v34
    v_dot2_f32_bf16 v36, v51, v11, v36
    v_dot2_f32_bf16 v35, v55, v7, v35
    v_dot2_f32_bf16 v37, v55, v11, v37
    s_mov_b32 s87, 0
    s_waitcnt lgkmcnt(0)
    v_readfirstlane_b32 s33, v46
    s_nop 0
    s_lshr_b32 s34, s33, 3
    s_lshl_b32 s34, s34, 2
    v_mov_b32 v46, s34
    ds_read_b32 v47, v46 offset:256
    v_add_f32_dpp v34, v34, v34 row_ror:8 row_mask:0xf bank_mask:0xf
    v_add_f32_dpp v35, v35, v35 row_ror:8 row_mask:0xf bank_mask:0xf
    v_add_f32_dpp v36, v36, v36 row_ror:8 row_mask:0xf bank_mask:0xf
    v_add_f32_dpp v37, v37, v37 row_ror:8 row_mask:0xf bank_mask:0xf
    v_add_f32_dpp v34, v34, v34 row_ror:4 row_mask:0xf bank_mask:0xf
    v_add_f32_dpp v35, v35, v35 row_ror:4 row_mask:0xf bank_mask:0xf
    v_add_f32_dpp v36, v36, v36 row_ror:4 row_mask:0xf bank_mask:0xf
    v_add_f32_dpp v37, v37, v37 row_ror:4 row_mask:0xf bank_mask:0xf
    v_add_f32_dpp v34, v34, v34 row_ror:2 row_mask:0xf bank_mask:0xf
    v_add_f32_dpp v35, v35, v35 row_ror:2 row_mask:0xf bank_mask:0xf
    v_add_f32_dpp v36, v36, v36 row_ror:2 row_mask:0xf bank_mask:0xf
    v_add_f32_dpp v37, v37, v37 row_ror:2 row_mask:0xf bank_mask:0xf
    v_add_f32_dpp v34, v34, v34 row_ror:1 row_mask:0xf bank_mask:0xf
    v_add_f32_dpp v35, v35, v35 row_ror:1 row_mask:0xf bank_mask:0xf
    v_add_f32_dpp v36, v36, v36 row_ror:1 row_mask:0xf bank_mask:0xf
    v_add_f32_dpp v37, v37, v37 row_ror:1 row_mask:0xf bank_mask:0xf
    v_mul_f32 v34, s31, v34
    v_mul_f32 v35, s31, v35
    v_mul_f32 v36, s31, v36
    v_mul_f32 v37, s31, v37
    v_max3_f32 v38, v30, v34, v35
    v_max3_f32 v39, v31, v36, v37
    v_sub_f32 v32, v30, v38
    v_sub_f32 v34, v34, v38
    v_sub_f32 v35, v35, v38
    v_sub_f32 v33, v31, v39
    v_sub_f32 v36, v36, v39
    v_sub_f32 v37, v37, v39
    v_exp_f32 v32, v32
    v_exp_f32 v34, v34
    v_exp_f32 v35, v35
    v_exp_f32 v33, v33
    v_exp_f32 v36, v36
    v_exp_f32 v37, v37
L_lk5:
    s_add_u32 s87, s87, 1
    s_waitcnt lgkmcnt(0)
    v_readfirstlane_b32 s35, v47
    s_nop 0
    s_cmp_lg_u32 s35, -1
    s_cbranch_scc1 L_lk6
    s_sleep 1
    ds_read_b32 v47, v46 offset:256
    s_cmp_lt_u32 s87, 1000000
    s_cbranch_scc1 L_lk5
    s_waitcnt lgkmcnt(0)
    s_mov_b32 s35, 400
L_lk6:
    s_and_b32 s33, s33, 7
    s_lshl_b32 s35, s35, 3
    s_add_u32 s35, s35, s33
    s_lshr_b32 s88, s35, 10
    s_min_u32 s88, s88, 3
    s_add_u32 s33, s35, s86
    s_and_b32 s33, s33, 0x3ff
    s_add_u32 s33, s33, s90
    s_lshr_b32 s35, s35, 11
    s_lshl_b32 s35, s35, 15
    s_add_u32 s35, s35, s33
    s_cmp_eq_u32 s88, 1
    s_cselect_b32 s16, s38, s48
    s_cselect_b32 s17, s39, s49
    s_cselect_b32 s20, s40, s50
    s_cselect_b32 s21, s41, s51
    s_cselect_b32 s18, s94, s95
    s_cselect_b32 s22, s94, s95
    s_lshl_b32 s32, s35, 11
    s_cmp_eq_u32 s88, 3
    s_cselect_b32 s32, s95, s32
    buffer_load_dwordx4 v[48:51], v1, s[16:19], s32 offen offset:0 nt
    buffer_load_dwordx4 v[52:55], v1, s[16:19], s32 offen offset:1024 nt
    v_mov_b32 v30, v38
    v_mov_b32 v31, v39
    v_pk_mul_f32 v[12:13], v[12:13], v[32:33] op_sel:[0,0] op_sel_hi:[1,0]
    v_pk_mul_f32 v[14:15], v[14:15], v[32:33] op_sel:[0,0] op_sel_hi:[1,0]
    v_pk_mul_f32 v[16:17], v[16:17], v[32:33] op_sel:[0,0] op_sel_hi:[1,0]
    v_pk_mul_f32 v[18:19], v[18:19], v[32:33] op_sel:[0,0] op_sel_hi:[1,0]
    v_fma_f32 v28, v28, v32, v34
    v_pk_mul_f32 v[20:21], v[20:21], v[32:33] op_sel:[0,1] op_sel_hi:[1,1]
    v_pk_mul_f32 v[22:23], v[22:23], v[32:33] op_sel:[0,1] op_sel_hi:[1,1]
    v_pk_mul_f32 v[24:25], v[24:25], v[32:33] op_sel:[0,1] op_sel_hi:[1,1]
    v_pk_mul_f32 v[26:27], v[26:27], v[32:33] op_sel:[0,1] op_sel_hi:[1,1]
    v_fma_f32 v29, v29, v33, v36
    v_add_f32 v28, v28, v35
    v_add_f32 v29, v29, v37
    s_waitcnt vmcnt(2)
    v_lshlrev_b32 v38, 16, v56
    v_and_b32 v39, 0xffff0000, v56
    v_lshlrev_b32 v40, 16, v57
    v_and_b32 v41, 0xffff0000, v57
    v_lshlrev_b32 v42, 16, v58
    v_and_b32 v43, 0xffff0000, v58
    v_lshlrev_b32 v44, 16, v59
    v_and_b32 v45, 0xffff0000, v59
    v_pk_fma_f32 v[12:13], v[38:39], v[34:35], v[12:13] op_sel:[0,0,0] op_sel_hi:[1,0,1]
    v_pk_fma_f32 v[14:15], v[40:41], v[34:35], v[14:15] op_sel:[0,0,0] op_sel_hi:[1,0,1]
    v_pk_fma_f32 v[16:17], v[42:43], v[34:35], v[16:17] op_sel:[0,0,0] op_sel_hi:[1,0,1]
    v_pk_fma_f32 v[18:19], v[44:45], v[34:35], v[18:19] op_sel:[0,0,0] op_sel_hi:[1,0,1]
    v_pk_fma_f32 v[20:21], v[38:39], v[36:37], v[20:21] op_sel:[0,0,0] op_sel_hi:[1,0,1]
    v_pk_fma_f32 v[22:23], v[40:41], v[36:37], v[22:23] op_sel:[0,0,0] op_sel_hi:[1,0,1]
    v_pk_fma_f32 v[24:25], v[42:43], v[36:37], v[24:25] op_sel:[0,0,0] op_sel_hi:[1,0,1]
    v_pk_fma_f32 v[26:27], v[44:45], v[36:37], v[26:27] op_sel:[0,0,0] op_sel_hi:[1,0,1]
    v_lshlrev_b32 v38, 16, v60
    v_and_b32 v39, 0xffff0000, v60
    v_lshlrev_b32 v40, 16, v61
    v_and_b32 v41, 0xffff0000, v61
    v_lshlrev_b32 v42, 16, v62
    v_and_b32 v43, 0xffff0000, v62
    v_lshlrev_b32 v44, 16, v63
    v_and_b32 v45, 0xffff0000, v63
    v_pk_fma_f32 v[12:13], v[38:39], v[34:35], v[12:13] op_sel:[0,1,0] op_sel_hi:[1,1,1]
    v_pk_fma_f32 v[14:15], v[40:41], v[34:35], v[14:15] op_sel:[0,1,0] op_sel_hi:[1,1,1]
    v_pk_fma_f32 v[16:17], v[42:43], v[34:35], v[16:17] op_sel:[0,1,0] op_sel_hi:[1,1,1]
    v_pk_fma_f32 v[18:19], v[44:45], v[34:35], v[18:19] op_sel:[0,1,0] op_sel_hi:[1,1,1]
    v_pk_fma_f32 v[20:21], v[38:39], v[36:37], v[20:21] op_sel:[0,1,0] op_sel_hi:[1,1,1]
    v_pk_fma_f32 v[22:23], v[40:41], v[36:37], v[22:23] op_sel:[0,1,0] op_sel_hi:[1,1,1]
    v_pk_fma_f32 v[24:25], v[42:43], v[36:37], v[24:25] op_sel:[0,1,0] op_sel_hi:[1,1,1]
    v_pk_fma_f32 v[26:27], v[44:45], v[36:37], v[26:27] op_sel:[0,1,0] op_sel_hi:[1,1,1]
    buffer_load_dwordx4 v[56:59], v1, s[20:23], s32 offen offset:0 nt
    buffer_load_dwordx4 v[60:63], v1, s[20:23], s32 offen offset:1024 nt
    s_branch L_nextA0
L_flush:
    s_nop 2
    v_and_b32 v46, 63, v0
    v_and_b32 v47, 15, v46
    v_lshrrev_b32 v46, 4, v46
    v_lshlrev_b32 v47, 5, v47
    v_lshl_add_u32 v47, v46, 3, v47
    s_mul_i32 s33, s30, 12672
    s_add_u32 s33, s33, s93
    v_add_u32 v47, s33, v47
    v_mov_b32 v46, s33
    s_sub_u32 s33, s33, s93
    s_add_u32 s33, s33, 8192
    v_and_b32 v44, 63, v0
    v_min_u32 v45, 11, v44
    v_mul_u32_u24 v42, 1056, v45
    v_add_u32 v42, s33, v42
    v_lshl_add_u32 v43, v44, 3, s33
    s_lshl_b32 s33, s30, 2
    v_mov_b32 v34, s33
    v_mov_b32 v35, 1
    v_mov_b32 v38, v30
    v_mov_b32 v39, v30
    s_nop 1
    v_permlane32_swap_b32 v38, v39
    v_max_f32 v38, v38, v39
    v_mov_b32 v39, v38
    s_nop 1
    v_permlane16_swap_b32 v38, v39
    v_max_f32 v38, v38, v39
    v_sub_f32 v32, v30, v38
    v_exp_f32 v32, v32
    s_nop 0
    v_pk_mul_f32 v[12:13], v[12:13], v[32:33] op_sel:[0,0] op_sel_hi:[1,0]
    v_pk_mul_f32 v[14:15], v[14:15], v[32:33] op_sel:[0,0] op_sel_hi:[1,0]
    v_pk_mul_f32 v[16:17], v[16:17], v[32:33] op_sel:[0,0] op_sel_hi:[1,0]
    v_pk_mul_f32 v[18:19], v[18:19], v[32:33] op_sel:[0,0] op_sel_hi:[1,0]
    v_mul_f32 v39, v28, v32
    v_mov_b32 v40, v39
    s_nop 1
    v_permlane32_swap_b32 v39, v40
    v_add_f32 v39, v39, v40
    v_mov_b32 v40, v39
    s_nop 1
    v_permlane16_swap_b32 v39, v40
    v_add_f32 v39, v39, v40
    v_permlane32_swap_b32 v12, v16
    v_permlane32_swap_b32 v13, v17
    v_permlane32_swap_b32 v14, v18
    v_permlane32_swap_b32 v15, v19
    v_add_f32 v12, v12, v16
    v_add_f32 v13, v13, v17
    v_add_f32 v14, v14, v18
    v_add_f32 v15, v15, v19
    s_nop 0
    v_permlane16_swap_b32 v12, v14
    v_permlane16_swap_b32 v13, v15
    v_add_f32 v12, v12, v14
    v_add_f32 v13, v13, v15
    ds_write_b64 v47, v[12:13] offset:0
    ds_write_b64 v46, v[38:39] offset:512
    s_bitcmp1_b32 s92, s30
    s_cbranch_scc0 L_flushed
    v_mov_b32 v38, v31
    v_mov_b32 v39, v31
    s_nop 1
    v_permlane32_swap_b32 v38, v39
    v_max_f32 v38, v38, v39
    v_mov_b32 v39, v38
    s_nop 1
    v_permlane16_swap_b32 v38, v39
    v_max_f32 v38, v38, v39
    v_sub_f32 v32, v31, v38
    v_exp_f32 v32, v32
    s_nop 0
    v_pk_mul_f32 v[20:21], v[20:21], v[32:33] op_sel:[0,0] op_sel_hi:[1,0]
    v_pk_mul_f32 v[22:23], v[22:23], v[32:33] op_sel:[0,0] op_sel_hi:[1,0]
    v_pk_mul_f32 v[24:25], v[24:25], v[32:33] op_sel:[0,0] op_sel_hi:[1,0]
    v_pk_mul_f32 v[26:27], v[26:27], v[32:33] op_sel:[0,0] op_sel_hi:[1,0]
    v_mul_f32 v39, v29, v32
    v_mov_b32 v40, v39
    s_nop 1
    v_permlane32_swap_b32 v39, v40
    v_add_f32 v39, v39, v40
    v_mov_b32 v40, v39
    s_nop 1
    v_permlane16_swap_b32 v39, v40
    v_add_f32 v39, v39, v40
    v_permlane32_swap_b32 v20, v24
    v_permlane32_swap_b32 v21, v25
    v_permlane32_swap_b32 v22, v26
    v_permlane32_swap_b32 v23, v27
    v_add_f32 v20, v20, v24
    v_add_f32 v21, v21, v25
    v_add_f32 v22, v22, v26
    v_add_f32 v23, v23, v27
    s_nop 0
    v_permlane16_swap_b32 v20, v22
    v_permlane16_swap_b32 v21, v23
    v_add_f32 v20, v20, v22
    v_add_f32 v21, v21, v23
    ds_write_b64 v47, v[20:21] offset:528
    ds_write_b64 v46, v[38:39] offset:1040
L_flushed:
    s_mov_b64 exec, 1
    ds_add_rtn_u32 v34, v34, v35 offset:8
    s_mov_b64 exec, -1
    ds_read_b64 v[92:93], v42 offset:512
    ds_read_b64 v[100:101], v43 offset:0
    ds_read_b64 v[102:103], v43 offset:1056
    ds_read_b64 v[104:105], v43 offset:2112
    ds_read_b64 v[106:107], v43 offset:3168
    ds_read_b64 v[108:109], v43 offset:4224
    ds_read_b64 v[110:111], v43 offset:5280
    ds_read_b64 v[112:113], v43 offset:6336
    ds_read_b64 v[114:115], v43 offset:7392
    ds_read_b64 v[116:117], v43 offset:8448
    ds_read_b64 v[118:119], v43 offset:9504
    ds_read_b64 v[120:121], v43 offset:10560
    ds_read_b64 v[122:123], v43 offset:11616
    v_mov_b32 v12, 0
    v_mov_b32 v13, 0
    v_mov_b32 v14, 0
    v_mov_b32 v15, 0
    v_mov_b32 v16, 0
    v_mov_b32 v17, 0
    v_mov_b32 v18, 0
    v_mov_b32 v19, 0
    v_mov_b32 v20, 0
    v_mov_b32 v21, 0
    v_mov_b32 v22, 0
    v_mov_b32 v23, 0
    v_mov_b32 v24, 0
    v_mov_b32 v25, 0
    v_mov_b32 v26, 0
    v_mov_b32 v27, 0
    v_mov_b32 v30, 0xff7fffff
    v_mov_b32 v28, 0
    v_mov_b32 v31, 0xff7fffff
    v_mov_b32 v29, 0
    s_add_u32 s34, s97, s30
    s_lshl_b32 s34, s34, 3
    s_add_u32 s34, s34, s91
    s_lshl_b32 s34, s34, 11
    s_add_u32 s34, s34, 524288
    v_cmp_eq_u32 vcc, v45, v44
    v_and_b32 v44, 1, v44
    v_cmp_eq_u32 s[84:85], 0, v44
    s_waitcnt lgkmcnt(12)
    v_readfirstlane_b32 s33, v34
    s_nop 0
    s_cmp_lg_u32 s33, 11
    s_cbranch_scc1 L_nojob
    v_mov_b32 v94, v92
    v_mov_b32 v96, 0
    v_mov_b32 v97, 0
    v_mov_b32 v98, s69
    v_max_f32_dpp v94, v94, v94 row_ror:8 row_mask:0xf bank_mask:0xf
    s_nop 1
    v_max_f32_dpp v94, v94, v94 row_ror:4 row_mask:0xf bank_mask:0xf
    s_nop 1
    v_max_f32_dpp v94, v94, v94 row_ror:2 row_mask:0xf bank_mask:0xf
    s_nop 1
    v_max_f32_dpp v94, v94, v94 row_ror:1 row_mask:0xf bank_mask:0xf
    v_sub_f32 v92, v92, v94
    v_exp_f32 v92, v92
    s_nop 0
    v_cndmask_b32 v92, 0, v92, vcc
    v_mul_f32 v95, v92, v93
    v_readlane_b32 s80, v92, 0
    v_readlane_b32 s81, v92, 1
    v_readlane_b32 s82, v92, 2
    v_readlane_b32 s83, v92, 3
    s_waitcnt lgkmcnt(0)
    v_add_f32_dpp v95, v95, v95 row_ror:8 row_mask:0xf bank_mask:0xf
    v_fma_f32 v96, v100, s80, v96
    v_fma_f32 v97, v101, s80, v97
    v_fma_f32 v96, v102, s81, v96
    v_fma_f32 v97, v103, s81, v97
    v_fma_f32 v96, v104, s82, v96
    v_fma_f32 v97, v105, s82, v97
    v_fma_f32 v96, v106, s83, v96
    v_fma_f32 v97, v107, s83, v97
    v_readlane_b32 s80, v92, 4
    v_readlane_b32 s81, v92, 5
    v_readlane_b32 s82, v92, 6
    v_readlane_b32 s83, v92, 7
    v_add_f32_dpp v95, v95, v95 row_ror:4 row_mask:0xf bank_mask:0xf
    v_fma_f32 v96, v108, s80, v96
    v_fma_f32 v97, v109, s80, v97
    v_fma_f32 v96, v110, s81, v96
    v_fma_f32 v97, v111, s81, v97
    v_fma_f32 v96, v112, s82, v96
    v_fma_f32 v97, v113, s82, v97
    v_fma_f32 v96, v114, s83, v96
    v_fma_f32 v97, v115, s83, v97
    v_readlane_b32 s80, v92, 8
    v_readlane_b32 s81, v92, 9
    v_readlane_b32 s82, v92, 10
    v_readlane_b32 s83, v92, 11
    v_add_f32_dpp v95, v95, v95 row_ror:2 row_mask:0xf bank_mask:0xf
    v_fma_f32 v96, v116, s80, v96
    v_fma_f32 v97, v117, s80, v97
    v_fma_f32 v96, v118, s81, v96
    v_fma_f32 v97, v119, s81, v97
    v_fma_f32 v96, v120, s82, v96
    v_fma_f32 v97, v121, s82, v97
    v_fma_f32 v96, v122, s83, v96
    v_fma_f32 v97, v123, s83, v97
    v_add_f32_dpp v95, v95, v95 row_ror:1 row_mask:0xf bank_mask:0xf
    v_readfirstlane_b32 s80, v94
    v_readfirstlane_b32 s81, v95
    s_nop 1
    v_mov_b32 v99, s81
    v_mov_b32 v94, s80
    v_cndmask_b32 v99, v99, v94, s[84:85]
    buffer_store_dwordx4 v[96:99], v1, s[24:27], s34 offen offset:0 sc1
    s_bitcmp1_b32 s92, s30
    s_cbranch_scc0 L_jobdone
    s_nop 1
    ds_read_b64 v[92:93], v42 offset:1040
    ds_read_b64 v[100:101], v43 offset:528
    ds_read_b64 v[102:103], v43 offset:1584
    ds_read_b64 v[104:105], v43 offset:2640
    ds_read_b64 v[106:107], v43 offset:3696
    ds_read_b64 v[108:109], v43 offset:4752
    ds_read_b64 v[110:111], v43 offset:5808
    ds_read_b64 v[112:113], v43 offset:6864
    ds_read_b64 v[114:115], v43 offset:7920
    ds_read_b64 v[116:117], v43 offset:8976
    ds_read_b64 v[118:119], v43 offset:10032
    ds_read_b64 v[120:121], v43 offset:11088
    ds_read_b64 v[122:123], v43 offset:12144
    s_waitcnt lgkmcnt(12)
    v_mov_b32 v94, v92
    v_mov_b32 v96, 0
    v_mov_b32 v97, 0
    v_mov_b32 v98, s69
    v_max_f32_dpp v94, v94, v94 row_ror:8 row_mask:0xf bank_mask:0xf
    s_nop 1
    v_max_f32_dpp v94, v94, v94 row_ror:4 row_mask:0xf bank_mask:0xf
    s_nop 1
    v_max_f32_dpp v94, v94, v94 row_ror:2 row_mask:0xf bank_mask:0xf
    s_nop 1
    v_max_f32_dpp v94, v94, v94 row_ror:1 row_mask:0xf bank_mask:0xf
    v_sub_f32 v92, v92, v94
    v_exp_f32 v92, v92
    s_nop 0
    v_cndmask_b32 v92, 0, v92, vcc
    v_mul_f32 v95, v92, v93
    v_readlane_b32 s80, v92, 0
    v_readlane_b32 s81, v92, 1
    v_readlane_b32 s82, v92, 2
    v_readlane_b32 s83, v92, 3
    s_waitcnt lgkmcnt(0)
    v_add_f32_dpp v95, v95, v95 row_ror:8 row_mask:0xf bank_mask:0xf
    v_fma_f32 v96, v100, s80, v96
    v_fma_f32 v97, v101, s80, v97
    v_fma_f32 v96, v102, s81, v96
    v_fma_f32 v97, v103, s81, v97
    v_fma_f32 v96, v104, s82, v96
    v_fma_f32 v97, v105, s82, v97
    v_fma_f32 v96, v106, s83, v96
    v_fma_f32 v97, v107, s83, v97
    v_readlane_b32 s80, v92, 4
    v_readlane_b32 s81, v92, 5
    v_readlane_b32 s82, v92, 6
    v_readlane_b32 s83, v92, 7
    v_add_f32_dpp v95, v95, v95 row_ror:4 row_mask:0xf bank_mask:0xf
    v_fma_f32 v96, v108, s80, v96
    v_fma_f32 v97, v109, s80, v97
    v_fma_f32 v96, v110, s81, v96
    v_fma_f32 v97, v111, s81, v97
    v_fma_f32 v96, v112, s82, v96
    v_fma_f32 v97, v113, s82, v97
    v_fma_f32 v96, v114, s83, v96
    v_fma_f32 v97, v115, s83, v97
    v_readlane_b32 s80, v92, 8
    v_readlane_b32 s81, v92, 9
    v_readlane_b32 s82, v92, 10
    v_readlane_b32 s83, v92, 11
    v_add_f32_dpp v95, v95, v95 row_ror:2 row_mask:0xf bank_mask:0xf
    v_fma_f32 v96, v116, s80, v96
    v_fma_f32 v97, v117, s80, v97
    v_fma_f32 v96, v118, s81, v96
    v_fma_f32 v97, v119, s81, v97
    v_fma_f32 v96, v120, s82, v96
    v_fma_f32 v97, v121, s82, v97
    v_fma_f32 v96, v122, s83, v96
    v_fma_f32 v97, v123, s83, v97
    v_add_f32_dpp v95, v95, v95 row_ror:1 row_mask:0xf bank_mask:0xf
    v_readfirstlane_b32 s80, v94
    v_readfirstlane_b32 s81, v95
    s_nop 1
    v_mov_b32 v99, s81
    v_mov_b32 v94, s80
    v_cndmask_b32 v99, v99, v94, s[84:85]
    buffer_store_dwordx4 v[96:99], v1, s[24:27], s34 offen offset:1024 sc1
L_jobdone:
L_nojob:
    s_cmp_eq_u32 s30, 2
    s_cbranch_scc1 L_end
    s_waitcnt lgkmcnt(0)
    s_add_u32 s30, s30, 1
    s_cmp_lg_u32 s30, s89
    s_cbranch_scc1 L_flush
    s_mov_b32 s87, 0
    s_lshl_b32 s33, s30, 2
    v_mov_b32 v46, s33
L_qwait:
    ds_read_b32 v47, v46 offset:16
    s_add_u32 s87, s87, 1
    s_waitcnt lgkmcnt(0)
    v_readfirstlane_b32 s33, v47
    s_nop 0
    s_cmp_eq_u32 s33, 128
    s_cbranch_scc1 L_qok
    s_sleep 1
    s_cmp_lt_u32 s87, 1000000
    s_cbranch_scc1 L_qwait
L_qok:
    s_lshl_b32 s33, s30, 9
    v_add_u32 v46, s33, v2
    ds_read_b128 v[4:7], v46 offset:1280
    ds_read_b128 v[8:11], v46 offset:1536
    s_waitcnt lgkmcnt(0)
    s_bitcmp1_b32 s92, s30
    s_cbranch_scc1 L_retA
    s_branch L_stepB0
L_retA:
    s_branch L_stepA0
L_helper:
    s_setprio 3
    s_cmp_ge_u32 s2, 128
    s_cselect_b32 s14, s46, s36
    s_cselect_b32 s15, s47, s37
    s_cselect_b32 s4, s4, s42
    s_cselect_b32 s5, s5, s43
    s_mov_b32 s20, s4
    s_and_b32 s21, s5, 0xffff
    s_mov_b32 s22, 0x480000
    s_mov_b32 s23, 0x20000
    s_mov_b32 s16, s14
    s_and_b32 s17, s15, 0xffff
    s_mov_b32 s18, 0x900
    s_mov_b32 s19, 0x20000
    s_and_b32 s33, s2, 1
    s_mul_i32 s33, s33, 288
    v_mul_u32_u24 v4, 72, v2
    v_lshrrev_b32 v5, 3, v3
    v_add3_u32 v4, v4, v5, s33
    v_lshlrev_b32 v5, 1, v4
    v_lshlrev_b32 v4, 13, v4
    v_and_b32 v6, 7, v3
    v_lshl_add_u32 v4, v6, 4, v4
    s_and_b32 s3, s2, 126
    s_lshl_b32 s3, s3, 6
    v_add_u32 v4, s3, v4
    s_mov_b32 s32, 0
    buffer_load_dwordx4 v[8:11], v4, s[20:23], s32 offen nt
    s_mov_b32 s32, 65536
    buffer_load_dwordx4 v[12:15], v4, s[20:23], s32 offen nt
    s_mov_b32 s32, 131072
    buffer_load_dwordx4 v[16:19], v4, s[20:23], s32 offen nt
    s_mov_b32 s32, 196608
    buffer_load_dwordx4 v[20:23], v4, s[20:23], s32 offen nt
    s_mov_b32 s32, 262144
    buffer_load_dwordx4 v[24:27], v4, s[20:23], s32 offen nt
    s_mov_b32 s32, 327680
    buffer_load_dwordx4 v[28:31], v4, s[20:23], s32 offen nt
    s_mov_b32 s32, 393216
    buffer_load_dwordx4 v[32:35], v4, s[20:23], s32 offen nt
    s_mov_b32 s32, 458752
    buffer_load_dwordx4 v[36:39], v4, s[20:23], s32 offen nt
    s_mov_b32 s32, 524288
    buffer_load_dwordx4 v[40:43], v4, s[20:23], s32 offen nt
    buffer_load_ushort v44, v5, s[16:19], 0 offen offset:0
    buffer_load_ushort v45, v5, s[16:19], 0 offen offset:1152
    buffer_load_ushort v46, v5, s[16:19], 0 offen offset:16
    buffer_load_ushort v47, v5, s[16:19], 0 offen offset:1168
    buffer_load_ushort v48, v5, s[16:19], 0 offen offset:32
    buffer_load_ushort v49, v5, s[16:19], 0 offen offset:1184
    buffer_load_ushort v50, v5, s[16:19], 0 offen offset:48
    buffer_load_ushort v51, v5, s[16:19], 0 offen offset:1200
    buffer_load_ushort v52, v5, s[16:19], 0 offen offset:64
    buffer_load_ushort v53, v5, s[16:19], 0 offen offset:1216
    buffer_load_ushort v54, v5, s[16:19], 0 offen offset:80
    buffer_load_ushort v55, v5, s[16:19], 0 offen offset:1232
    buffer_load_ushort v56, v5, s[16:19], 0 offen offset:96
    buffer_load_ushort v57, v5, s[16:19], 0 offen offset:1248
    buffer_load_ushort v58, v5, s[16:19], 0 offen offset:112
    buffer_load_ushort v59, v5, s[16:19], 0 offen offset:1264
    buffer_load_ushort v60, v5, s[16:19], 0 offen offset:128
    buffer_load_ushort v61, v5, s[16:19], 0 offen offset:1280
    v_lshlrev_b32 v6, 2, v0
    v_lshl_add_u32 v7, v0, 3, s91
    v_cmp_gt_u32 vcc, 32, v0
    s_nop 1
    v_cndmask_b32 v7, -1, v7, vcc
    ds_write_b32 v6, v7 offset:256
    v_mov_b32 v7, 60
    v_cmp_eq_u32 vcc, 1, v3
    s_nop 1
    v_cndmask_b32 v7, 0, v7, vcc
    v_and_b32 v6, 15, v3
    v_lshlrev_b32 v6, 2, v6
    v_cmp_gt_u32 vcc, 16, v3
    s_nop 0
    s_and_saveexec_b64 s[34:35], vcc
    ds_write_b32 v6, v7 offset:0
    s_mov_b64 exec, s[34:35]
    v_mov_b32 v7, 1
    s_waitcnt lgkmcnt(0)
    s_barrier
    s_mov_b32 s52, s10
    s_and_b32 s53, s11, 0xffff
    s_mov_b32 s54, 0x100
    s_mov_b32 s55, 0x20000
    s_cmp_eq_u32 s65, 0
    s_cselect_b32 s14, s44, s6
    s_cselect_b32 s15, s45, s7
    s_mov_b32 s56, s14
    s_and_b32 s57, s15, 0xffff
    s_mov_b32 s58, 0x480000
    s_mov_b32 s59, 0x20000
    s_add_u32 s69, s69, 1
    s_mul_i32 s67, s96, 256
    s_add_u32 s67, s67, 266240
    s_lshl_b32 s68, s69, 8
    v_mov_b32 v62, 0
    v_mov_b32 v63, 0
    v_mov_b32 v64, 0
    v_mov_b32 v65, 0
    v_mov_b32 v66, 0
    v_mov_b32 v67, 0
    v_mov_b32 v68, 0
    v_mov_b32 v69, 0
    v_mov_b32 v70, 0
    v_mov_b32 v71, 0
    v_mov_b32 v72, 0
    v_mov_b32 v73, 0
    v_mov_b32 v74, 0
    v_mov_b32 v75, 0
    v_mov_b32 v76, 0
    v_mov_b32 v77, 0
    s_waitcnt vmcnt(0)
    v_lshlrev_b32 v44, 16, v44
    v_lshlrev_b32 v45, 16, v45
    v_lshlrev_b32 v46, 16, v46
    v_lshlrev_b32 v47, 16, v47
    v_lshlrev_b32 v48, 16, v48
    v_lshlrev_b32 v49, 16, v49
    v_lshlrev_b32 v50, 16, v50
    v_lshlrev_b32 v51, 16, v51
    v_lshlrev_b32 v52, 16, v52
    v_lshlrev_b32 v53, 16, v53
    v_lshlrev_b32 v54, 16, v54
    v_lshlrev_b32 v55, 16, v55
    v_lshlrev_b32 v56, 16, v56
    v_lshlrev_b32 v57, 16, v57
    v_lshlrev_b32 v58, 16, v58
    v_lshlrev_b32 v59, 16, v59
    v_lshlrev_b32 v60, 16, v60
    v_lshlrev_b32 v61, 16, v61
    v_lshlrev_b32 v78, 16, v8
    v_and_b32 v79, 0xffff0000, v8
    v_lshlrev_b32 v80, 16, v9
    v_and_b32 v81, 0xffff0000, v9
    v_lshlrev_b32 v82, 16, v10
    v_and_b32 v83, 0xffff0000, v10
    v_lshlrev_b32 v84, 16, v11
    v_and_b32 v85, 0xffff0000, v11
    v_pk_fma_f32 v[62:63], v[78:79], v[44:45], v[62:63] op_sel:[0,0,0] op_sel_hi:[1,0,1]
    v_pk_fma_f32 v[64:65], v[80:81], v[44:45], v[64:65] op_sel:[0,0,0] op_sel_hi:[1,0,1]
    v_pk_fma_f32 v[66:67], v[82:83], v[44:45], v[66:67] op_sel:[0,0,0] op_sel_hi:[1,0,1]
    v_pk_fma_f32 v[68:69], v[84:85], v[44:45], v[68:69] op_sel:[0,0,0] op_sel_hi:[1,0,1]
    v_pk_fma_f32 v[70:71], v[78:79], v[44:45], v[70:71] op_sel:[0,1,0] op_sel_hi:[1,1,1]
    v_pk_fma_f32 v[72:73], v[80:81], v[44:45], v[72:73] op_sel:[0,1,0] op_sel_hi:[1,1,1]
    v_pk_fma_f32 v[74:75], v[82:83], v[44:45], v[74:75] op_sel:[0,1,0] op_sel_hi:[1,1,1]
    v_pk_fma_f32 v[76:77], v[84:85], v[44:45], v[76:77] op_sel:[0,1,0] op_sel_hi:[1,1,1]
    v_lshlrev_b32 v78, 16, v12
    v_and_b32 v79, 0xffff0000, v12
    v_lshlrev_b32 v80, 16, v13
    v_and_b32 v81, 0xffff0000, v13
    v_lshlrev_b32 v82, 16, v14
    v_and_b32 v83, 0xffff0000, v14
    v_lshlrev_b32 v84, 16, v15
    v_and_b32 v85, 0xffff0000, v15
    v_pk_fma_f32 v[62:63], v[78:79], v[46:47], v[62:63] op_sel:[0,0,0] op_sel_hi:[1,0,1]
    v_pk_fma_f32 v[64:65], v[80:81], v[46:47], v[64:65] op_sel:[0,0,0] op_sel_hi:[1,0,1]
    v_pk_fma_f32 v[66:67], v[82:83], v[46:47], v[66:67] op_sel:[0,0,0] op_sel_hi:[1,0,1]
    v_pk_fma_f32 v[68:69], v[84:85], v[46:47], v[68:69] op_sel:[0,0,0] op_sel_hi:[1,0,1]
    v_pk_fma_f32 v[70:71], v[78:79], v[46:47], v[70:71] op_sel:[0,1,0] op_sel_hi:[1,1,1]
    v_pk_fma_f32 v[72:73], v[80:81], v[46:47], v[72:73] op_sel:[0,1,0] op_sel_hi:[1,1,1]
    v_pk_fma_f32 v[74:75], v[82:83], v[46:47], v[74:75] op_sel:[0,1,0] op_sel_hi:[1,1,1]
    v_pk_fma_f32 v[76:77], v[84:85], v[46:47], v[76:77] op_sel:[0,1,0] op_sel_hi:[1,1,1]
    v_lshlrev_b32 v78, 16, v16
    v_and_b32 v79, 0xffff0000, v16
    v_lshlrev_b32 v80, 16, v17
    v_and_b32 v81, 0xffff0000, v17
    v_lshlrev_b32 v82, 16, v18
    v_and_b32 v83, 0xffff0000, v18
    v_lshlrev_b32 v84, 16, v19
    v_and_b32 v85, 0xffff0000, v19
    v_pk_fma_f32 v[62:63], v[78:79], v[48:49], v[62:63] op_sel:[0,0,0] op_sel_hi:[1,0,1]
    v_pk_fma_f32 v[64:65], v[80:81], v[48:49], v[64:65] op_sel:[0,0,0] op_sel_hi:[1,0,1]
    v_pk_fma_f32 v[66:67], v[82:83], v[48:49], v[66:67] op_sel:[0,0,0] op_sel_hi:[1,0,1]
    v_pk_fma_f32 v[68:69], v[84:85], v[48:49], v[68:69] op_sel:[0,0,0] op_sel_hi:[1,0,1]
    v_pk_fma_f32 v[70:71], v[78:79], v[48:49], v[70:71] op_sel:[0,1,0] op_sel_hi:[1,1,1]
    v_pk_fma_f32 v[72:73], v[80:81], v[48:49], v[72:73] op_sel:[0,1,0] op_sel_hi:[1,1,1]
    v_pk_fma_f32 v[74:75], v[82:83], v[48:49], v[74:75] op_sel:[0,1,0] op_sel_hi:[1,1,1]
    v_pk_fma_f32 v[76:77], v[84:85], v[48:49], v[76:77] op_sel:[0,1,0] op_sel_hi:[1,1,1]
    v_lshlrev_b32 v78, 16, v20
    v_and_b32 v79, 0xffff0000, v20
    v_lshlrev_b32 v80, 16, v21
    v_and_b32 v81, 0xffff0000, v21
    v_lshlrev_b32 v82, 16, v22
    v_and_b32 v83, 0xffff0000, v22
    v_lshlrev_b32 v84, 16, v23
    v_and_b32 v85, 0xffff0000, v23
    v_pk_fma_f32 v[62:63], v[78:79], v[50:51], v[62:63] op_sel:[0,0,0] op_sel_hi:[1,0,1]
    v_pk_fma_f32 v[64:65], v[80:81], v[50:51], v[64:65] op_sel:[0,0,0] op_sel_hi:[1,0,1]
    v_pk_fma_f32 v[66:67], v[82:83], v[50:51], v[66:67] op_sel:[0,0,0] op_sel_hi:[1,0,1]
    v_pk_fma_f32 v[68:69], v[84:85], v[50:51], v[68:69] op_sel:[0,0,0] op_sel_hi:[1,0,1]
    v_pk_fma_f32 v[70:71], v[78:79], v[50:51], v[70:71] op_sel:[0,1,0] op_sel_hi:[1,1,1]
    v_pk_fma_f32 v[72:73], v[80:81], v[50:51], v[72:73] op_sel:[0,1,0] op_sel_hi:[1,1,1]
    v_pk_fma_f32 v[74:75], v[82:83], v[50:51], v[74:75] op_sel:[0,1,0] op_sel_hi:[1,1,1]
    v_pk_fma_f32 v[76:77], v[84:85], v[50:51], v[76:77] op_sel:[0,1,0] op_sel_hi:[1,1,1]
    v_lshlrev_b32 v78, 16, v24
    v_and_b32 v79, 0xffff0000, v24
    v_lshlrev_b32 v80, 16, v25
    v_and_b32 v81, 0xffff0000, v25
    v_lshlrev_b32 v82, 16, v26
    v_and_b32 v83, 0xffff0000, v26
    v_lshlrev_b32 v84, 16, v27
    v_and_b32 v85, 0xffff0000, v27
    v_pk_fma_f32 v[62:63], v[78:79], v[52:53], v[62:63] op_sel:[0,0,0] op_sel_hi:[1,0,1]
    v_pk_fma_f32 v[64:65], v[80:81], v[52:53], v[64:65] op_sel:[0,0,0] op_sel_hi:[1,0,1]
    v_pk_fma_f32 v[66:67], v[82:83], v[52:53], v[66:67] op_sel:[0,0,0] op_sel_hi:[1,0,1]
    v_pk_fma_f32 v[68:69], v[84:85], v[52:53], v[68:69] op_sel:[0,0,0] op_sel_hi:[1,0,1]
    v_pk_fma_f32 v[70:71], v[78:79], v[52:53], v[70:71] op_sel:[0,1,0] op_sel_hi:[1,1,1]
    v_pk_fma_f32 v[72:73], v[80:81], v[52:53], v[72:73] op_sel:[0,1,0] op_sel_hi:[1,1,1]
    v_pk_fma_f32 v[74:75], v[82:83], v[52:53], v[74:75] op_sel:[0,1,0] op_sel_hi:[1,1,1]
    v_pk_fma_f32 v[76:77], v[84:85], v[52:53], v[76:77] op_sel:[0,1,0] op_sel_hi:[1,1,1]
    v_lshlrev_b32 v78, 16, v28
    v_and_b32 v79, 0xffff0000, v28
    v_lshlrev_b32 v80, 16, v29
    v_and_b32 v81, 0xffff0000, v29
    v_lshlrev_b32 v82, 16, v30
    v_and_b32 v83, 0xffff0000, v30
    v_lshlrev_b32 v84, 16, v31
    v_and_b32 v85, 0xffff0000, v31
    v_pk_fma_f32 v[62:63], v[78:79], v[54:55], v[62:63] op_sel:[0,0,0] op_sel_hi:[1,0,1]
    v_pk_fma_f32 v[64:65], v[80:81], v[54:55], v[64:65] op_sel:[0,0,0] op_sel_hi:[1,0,1]
    v_pk_fma_f32 v[66:67], v[82:83], v[54:55], v[66:67] op_sel:[0,0,0] op_sel_hi:[1,0,1]
    v_pk_fma_f32 v[68:69], v[84:85], v[54:55], v[68:69] op_sel:[0,0,0] op_sel_hi:[1,0,1]
    v_pk_fma_f32 v[70:71], v[78:79], v[54:55], v[70:71] op_sel:[0,1,0] op_sel_hi:[1,1,1]
    v_pk_fma_f32 v[72:73], v[80:81], v[54:55], v[72:73] op_sel:[0,1,0] op_sel_hi:[1,1,1]
    v_pk_fma_f32 v[74:75], v[82:83], v[54:55], v[74:75] op_sel:[0,1,0] op_sel_hi:[1,1,1]
    v_pk_fma_f32 v[76:77], v[84:85], v[54:55], v[76:77] op_sel:[0,1,0] op_sel_hi:[1,1,1]
    v_lshlrev_b32 v78, 16, v32
    v_and_b32 v79, 0xffff0000, v32
    v_lshlrev_b32 v80, 16, v33
    v_and_b32 v81, 0xffff0000, v33
    v_lshlrev_b32 v82, 16, v34
    v_and_b32 v83, 0xffff0000, v34
    v_lshlrev_b32 v84, 16, v35
    v_and_b32 v85, 0xffff0000, v35
    v_pk_fma_f32 v[62:63], v[78:79], v[56:57], v[62:63] op_sel:[0,0,0] op_sel_hi:[1,0,1]
    v_pk_fma_f32 v[64:65], v[80:81], v[56:57], v[64:65] op_sel:[0,0,0] op_sel_hi:[1,0,1]
    v_pk_fma_f32 v[66:67], v[82:83], v[56:57], v[66:67] op_sel:[0,0,0] op_sel_hi:[1,0,1]
    v_pk_fma_f32 v[68:69], v[84:85], v[56:57], v[68:69] op_sel:[0,0,0] op_sel_hi:[1,0,1]
    v_pk_fma_f32 v[70:71], v[78:79], v[56:57], v[70:71] op_sel:[0,1,0] op_sel_hi:[1,1,1]
    v_pk_fma_f32 v[72:73], v[80:81], v[56:57], v[72:73] op_sel:[0,1,0] op_sel_hi:[1,1,1]
    v_pk_fma_f32 v[74:75], v[82:83], v[56:57], v[74:75] op_sel:[0,1,0] op_sel_hi:[1,1,1]
    v_pk_fma_f32 v[76:77], v[84:85], v[56:57], v[76:77] op_sel:[0,1,0] op_sel_hi:[1,1,1]
    v_lshlrev_b32 v78, 16, v36
    v_and_b32 v79, 0xffff0000, v36
    v_lshlrev_b32 v80, 16, v37
    v_and_b32 v81, 0xffff0000, v37
    v_lshlrev_b32 v82, 16, v38
    v_and_b32 v83, 0xffff0000, v38
    v_lshlrev_b32 v84, 16, v39
    v_and_b32 v85, 0xffff0000, v39
    v_pk_fma_f32 v[62:63], v[78:79], v[58:59], v[62:63] op_sel:[0,0,0] op_sel_hi:[1,0,1]
    v_pk_fma_f32 v[64:65], v[80:81], v[58:59], v[64:65] op_sel:[0,0,0] op_sel_hi:[1,0,1]
    v_pk_fma_f32 v[66:67], v[82:83], v[58:59], v[66:67] op_sel:[0,0,0] op_sel_hi:[1,0,1]
    v_pk_fma_f32 v[68:69], v[84:85], v[58:59], v[68:69] op_sel:[0,0,0] op_sel_hi:[1,0,1]
    v_pk_fma_f32 v[70:71], v[78:79], v[58:59], v[70:71] op_sel:[0,1,0] op_sel_hi:[1,1,1]
    v_pk_fma_f32 v[72:73], v[80:81], v[58:59], v[72:73] op_sel:[0,1,0] op_sel_hi:[1,1,1]
    v_pk_fma_f32 v[74:75], v[82:83], v[58:59], v[74:75] op_sel:[0,1,0] op_sel_hi:[1,1,1]
    v_pk_fma_f32 v[76:77], v[84:85], v[58:59], v[76:77] op_sel:[0,1,0] op_sel_hi:[1,1,1]
    v_lshlrev_b32 v78, 16, v40
    v_and_b32 v79, 0xffff0000, v40
    v_lshlrev_b32 v80, 16, v41
    v_and_b32 v81, 0xffff0000, v41
    v_lshlrev_b32 v82, 16, v42
    v_and_b32 v83, 0xffff0000, v42
    v_lshlrev_b32 v84, 16, v43
    v_and_b32 v85, 0xffff0000, v43
    v_pk_fma_f32 v[62:63], v[78:79], v[60:61], v[62:63] op_sel:[0,0,0] op_sel_hi:[1,0,1]
    v_pk_fma_f32 v[64:65], v[80:81], v[60:61], v[64:65] op_sel:[0,0,0] op_sel_hi:[1,0,1]
    v_pk_fma_f32 v[66:67], v[82:83], v[60:61], v[66:67] op_sel:[0,0,0] op_sel_hi:[1,0,1]
    v_pk_fma_f32 v[68:69], v[84:85], v[60:61], v[68:69] op_sel:[0,0,0] op_sel_hi:[1,0,1]
    v_pk_fma_f32 v[70:71], v[78:79], v[60:61], v[70:71] op_sel:[0,1,0] op_sel_hi:[1,1,1]
    v_pk_fma_f32 v[72:73], v[80:81], v[60:61], v[72:73] op_sel:[0,1,0] op_sel_hi:[1,1,1]
    v_pk_fma_f32 v[74:75], v[82:83], v[60:61], v[74:75] op_sel:[0,1,0] op_sel_hi:[1,1,1]
    v_pk_fma_f32 v[76:77], v[84:85], v[60:61], v[76:77] op_sel:[0,1,0] op_sel_hi:[1,1,1]
    v_permlane32_swap_b32 v62, v70
    v_permlane32_swap_b32 v63, v71
    v_permlane32_swap_b32 v64, v72
    v_permlane32_swap_b32 v65, v73
    v_permlane32_swap_b32 v66, v74
    v_permlane32_swap_b32 v67, v75
    v_permlane32_swap_b32 v68, v76
    v_permlane32_swap_b32 v69, v77
    v_add_f32 v62, v62, v70
    v_add_f32 v63, v63, v71
    v_add_f32 v64, v64, v72
    v_add_f32 v65, v65, v73
    v_add_f32 v66, v66, v74
    v_add_f32 v67, v67, v75
    v_add_f32 v68, v68, v76
    v_add_f32 v69, v69, v77
    v_permlane16_swap_b32 v62, v66
    v_permlane16_swap_b32 v63, v67
    v_permlane16_swap_b32 v64, v68
    v_permlane16_swap_b32 v65, v69
    v_add_f32 v62, v62, v66
    v_add_f32 v63, v63, v67
    v_add_f32 v64, v64, v68
    v_add_f32 v65, v65, v69
    v_add_f32_dpp v62, v62, v62 row_ror:8 row_mask:0xf bank_mask:0xf
    v_add_f32_dpp v63, v63, v63 row_ror:8 row_mask:0xf bank_mask:0xf
    v_add_f32_dpp v64, v64, v64 row_ror:8 row_mask:0xf bank_mask:0xf
    v_add_f32_dpp v65, v65, v65 row_ror:8 row_mask:0xf bank_mask:0xf
    v_lshrrev_b32 v4, 4, v3
    v_lshrrev_b32 v5, 1, v4
    v_and_b32 v4, 1, v4
    v_lshlrev_b32 v6, 9, v2
    v_lshl_add_u32 v6, v5, 8, v6
    v_lshl_add_u32 v6, v4, 4, v6
    v_and_b32 v4, 7, v3
    v_lshl_add_u32 v6, v4, 5, v6
    ds_write_b64 v6, v[62:63] offset:2816
    ds_write_b64 v6, v[64:65] offset:2824
    v_mov_b32 v6, 0
    s_waitcnt lgkmcnt(0)
    ds_add_u32 v6, v7 offset:0
    s_cmp_lt_u32 s28, 2
    s_cbranch_scc1 L_h01
    s_cmp_eq_u32 s28, 2
    s_cbranch_scc1 L_h2
L_spin1:
    ds_read_b32 v8, v6 offset:0
    s_waitcnt lgkmcnt(0)
    v_readfirstlane_b32 s33, v8
    s_nop 0
    s_cmp_lg_u32 s33, 256
    s_cbranch_scc1 L_spin1
    v_lshlrev_b32 v6, 3, v3
    ds_read_b64 v[8:9], v6 offset:2816
    ds_read_b64 v[10:11], v6 offset:3328
    ds_read_b64 v[12:13], v6 offset:3840
    ds_read_b64 v[14:15], v6 offset:4352
    s_lshl_b32 s32, s2, 10
    v_mov_b32 v18, s69
    v_mov_b32 v19, s69
    s_waitcnt lgkmcnt(0)
    v_pk_add_f32 v[8:9], v[8:9], v[10:11]
    v_pk_add_f32 v[12:13], v[12:13], v[14:15]
    v_pk_add_f32 v[16:17], v[8:9], v[12:13]
    buffer_store_dwordx4 v[16:19], v1, s[24:27], s32 offen offset:0 sc1
    v_mov_b32 v118, s69
    v_mov_b32 v6, 0
    s_mov_b64 exec, 1
L_nobump:
    s_mov_b64 exec, -1
    s_branch L_wo
L_h2:
    s_cmp_lg_u32 s91, 0
    s_cbranch_scc1 L_h2b
    v_mov_b32 v8, s68
    s_mov_b64 exec, 1
    buffer_store_dword v8, v6, s[24:27], s67 offen sc1
    s_mov_b64 exec, -1
L_h2b:
    s_waitcnt lgkmcnt(0)
    s_cmp_lg_u32 s2, 255
    s_cbranch_scc1 L_nobump2
    s_mov_b32 s87, 0
    v_mov_b32 v9, s69
L_bumpwait:
    v_lshlrev_b32 v8, 10, v3
    s_mov_b32 s33, 0
    buffer_load_dwordx2 v[10:11], v8, s[24:27], s33 offen offset:8 sc1
    s_mov_b32 s33, 65536
    buffer_load_dwordx2 v[12:13], v8, s[24:27], s33 offen offset:8 sc1
    s_mov_b32 s33, 131072
    buffer_load_dwordx2 v[14:15], v8, s[24:27], s33 offen offset:8 sc1
    s_mov_b32 s33, 196608
    buffer_load_dwordx2 v[16:17], v8, s[24:27], s33 offen offset:8 sc1
    s_add_u32 s87, s87, 1
    s_waitcnt vmcnt(0)
    v_xor_b32 v10, s69, v10
    v_xor_b32 v11, s69, v11
    v_xor_b32 v12, s69, v12
    v_xor_b32 v13, s69, v13
    v_xor_b32 v14, s69, v14
    v_xor_b32 v15, s69, v15
    v_xor_b32 v16, s69, v16
    v_xor_b32 v17, s69, v17
    v_or3_b32 v10, v10, v11, v12
    v_or3_b32 v13, v13, v14, v15
    v_or3_b32 v10, v10, v16, v17
    v_or_b32 v10, v10, v13
    v_cmp_ne_u32 vcc, 0, v10
    s_nop 0
    s_cbranch_vccz L_bump
    s_sleep 127
    s_cmp_lt_u32 s87, 100000
    s_cbranch_scc1 L_bumpwait
L_bump:
    s_mov_b32 s33, 262144
    s_mov_b64 exec, 1
    buffer_store_dword v9, v6, s[24:27], s33 offen sc1
    s_mov_b64 exec, -1
L_nobump2:
    s_branch L_wo
L_h01:
    v_and_b32 v8, 31, v3
    v_lshlrev_b32 v8, 4, v8
    v_lshrrev_b32 v9, 5, v3
    v_lshl_add_u32 v8, v9, 11, v8
    s_add_u32 s33, s96, 32
    s_lshl_b32 s33, s33, 12
    s_lshl_b32 s34, s28, 9
    v_lshlrev_b32 v10, 2, v3
    v_lshl_add_u32 v10, v2, 10, v10
    s_add_u32 s75, s33, s34
    s_mov_b32 s33, 0
L_pollq0:
    buffer_load_dwordx4 v[12:15], v8, s[24:27], s75 offen offset:0 sc1
    buffer_load_dwordx4 v[16:19], v8, s[24:27], s75 offen offset:1024 sc1
    s_add_u32 s33, s33, 1
    s_waitcnt vmcnt(0)
    v_cmp_eq_u32 vcc, s69, v14
    v_cmp_eq_u32 s[76:77], s69, v18
    s_nop 0
    s_and_b64 s[76:77], vcc, s[76:77]
    s_cmp_eq_u64 s[76:77], -1
    s_cbranch_scc1 L_pollqd0
    s_sleep 1
    s_cmp_lt_u32 s33, 100000
    s_cbranch_scc1 L_pollq0
L_pollqd0:
    v_pk_add_f32 v[12:13], v[12:13], v[16:17]
    v_cvt_pk_bf16_f32 v12, v12, v13
    ds_write_b32 v10, v12 offset:1280
    s_waitcnt lgkmcnt(0)
    s_cmp_lg_u32 s28, 0
    s_cbranch_scc1 L_q0set
    ds_write_b32 v6, v7 offset:32
L_q0set:
    s_and_b32 s33, s96, 15
    s_lshl_b32 s33, s33, 1
    s_add_u32 s33, s33, s28
    s_lshl_b32 s33, s33, 12
    s_lshr_b32 s34, s96, 4
    s_lshl_b32 s34, s34, 9
    v_lshlrev_b32 v10, 2, v3
    v_lshl_add_u32 v10, v2, 8, v10
    s_add_u32 s75, s33, s34
    s_mov_b32 s33, 0
L_pollq1:
    buffer_load_dwordx4 v[12:15], v8, s[24:27], s75 offen offset:0 sc1
    buffer_load_dwordx4 v[16:19], v8, s[24:27], s75 offen offset:1024 sc1
    s_add_u32 s33, s33, 1
    s_waitcnt vmcnt(0)
    v_cmp_eq_u32 vcc, s69, v14
    v_cmp_eq_u32 s[76:77], s69, v18
    s_nop 0
    s_and_b64 s[76:77], vcc, s[76:77]
    s_cmp_eq_u64 s[76:77], -1
    s_cbranch_scc1 L_pollqd1
    s_sleep 1
    s_cmp_lt_u32 s33, 100000
    s_cbranch_scc1 L_pollq1
L_pollqd1:
    v_pk_add_f32 v[12:13], v[12:13], v[16:17]
    v_cvt_pk_bf16_f32 v12, v12, v13
    ds_write_b32 v10, v12 offset:1792
    s_waitcnt lgkmcnt(0)
    ds_add_u32 v6, v7 offset:20
    ds_add_u32 v6, v7 offset:24
L_wo:
    s_cmp_eq_u32 s64, 0
    s_cbranch_scc1 L_nowo
    s_lshl_b32 s45, s78, 2
    s_add_u32 s45, s45, s28
    s_lshl_b32 s35, s45, 7
    v_lshrrev_b32 v4, 3, v3
    v_lshl_add_u32 v4, v4, 4, s35
    v_mul_u32_u24 v4, 1152, v4
    v_and_b32 v5, 7, v3
    v_lshl_add_u32 v4, v5, 4, v4
    v_add_u32 v4, s66, v4
    s_mov_b32 s33, 0
    buffer_load_dwordx4 v[8:11], v4, s[56:59], s33 offen nt
    s_mov_b32 s33, 1152
    buffer_load_dwordx4 v[12:15], v4, s[56:59], s33 offen nt
    s_mov_b32 s33, 2304
    buffer_load_dwordx4 v[16:19], v4, s[56:59], s33 offen nt
    s_mov_b32 s33, 3456
    buffer_load_dwordx4 v[20:23], v4, s[56:59], s33 offen nt
    s_mov_b32 s33, 4608
    buffer_load_dwordx4 v[24:27], v4, s[56:59], s33 offen nt
    s_mov_b32 s33, 5760
    buffer_load_dwordx4 v[28:31], v4, s[56:59], s33 offen nt
    s_mov_b32 s33, 6912
    buffer_load_dwordx4 v[32:35], v4, s[56:59], s33 offen nt
    s_mov_b32 s33, 8064
    buffer_load_dwordx4 v[36:39], v4, s[56:59], s33 offen nt
    s_mov_b32 s33, 9216
    buffer_load_dwordx4 v[40:43], v4, s[56:59], s33 offen nt
    s_mov_b32 s33, 10368
    buffer_load_dwordx4 v[44:47], v4, s[56:59], s33 offen nt
    s_mov_b32 s33, 11520
    buffer_load_dwordx4 v[48:51], v4, s[56:59], s33 offen nt
    s_mov_b32 s33, 12672
    buffer_load_dwordx4 v[52:55], v4, s[56:59], s33 offen nt
    s_mov_b32 s33, 13824
    buffer_load_dwordx4 v[56:59], v4, s[56:59], s33 offen nt
    s_mov_b32 s33, 14976
    buffer_load_dwordx4 v[60:63], v4, s[56:59], s33 offen nt
    s_mov_b32 s33, 16128
    buffer_load_dwordx4 v[64:67], v4, s[56:59], s33 offen nt
    s_mov_b32 s33, 17280
    buffer_load_dwordx4 v[68:71], v4, s[56:59], s33 offen nt
L_woissued:
    s_mov_b32 s34, 0x05040100
    s_mov_b32 s35, 0x07060302
    s_waitcnt vmcnt(0)
    v_perm_b32 v120, v12, v8, s34
    v_perm_b32 v12, v12, v8, s35
    v_perm_b32 v121, v13, v9, s34
    v_perm_b32 v13, v13, v9, s35
    v_perm_b32 v122, v14, v10, s34
    v_perm_b32 v14, v14, v10, s35
    v_perm_b32 v123, v15, v11, s34
    v_perm_b32 v15, v15, v11, s35
    v_mov_b32 v8, v120
    v_mov_b32 v9, v121
    v_mov_b32 v10, v122
    v_mov_b32 v11, v123
    v_perm_b32 v120, v20, v16, s34
    v_perm_b32 v20, v20, v16, s35
    v_perm_b32 v121, v21, v17, s34
    v_perm_b32 v21, v21, v17, s35
    v_perm_b32 v122, v22, v18, s34
    v_perm_b32 v22, v22, v18, s35
    v_perm_b32 v123, v23, v19, s34
    v_perm_b32 v23, v23, v19, s35
    v_mov_b32 v16, v120
    v_mov_b32 v17, v121
    v_mov_b32 v18, v122
    v_mov_b32 v19, v123
    v_perm_b32 v120, v28, v24, s34
    v_perm_b32 v28, v28, v24, s35
    v_perm_b32 v121, v29, v25, s34
    v_perm_b32 v29, v29, v25, s35
    v_perm_b32 v122, v30, v26, s34
    v_perm_b32 v30, v30, v26, s35
    v_perm_b32 v123, v31, v27, s34
    v_perm_b32 v31, v31, v27, s35
    v_mov_b32 v24, v120
    v_mov_b32 v25, v121
    v_mov_b32 v26, v122
    v_mov_b32 v27, v123
    v_perm_b32 v120, v36, v32, s34
    v_perm_b32 v36, v36, v32, s35
    v_perm_b32 v121, v37, v33, s34
    v_perm_b32 v37, v37, v33, s35
    v_perm_b32 v122, v38, v34, s34
    v_perm_b32 v38, v38, v34, s35
    v_perm_b32 v123, v39, v35, s34
    v_perm_b32 v39, v39, v35, s35
    v_mov_b32 v32, v120
    v_mov_b32 v33, v121
    v_mov_b32 v34, v122
    v_mov_b32 v35, v123
    v_perm_b32 v120, v44, v40, s34
    v_perm_b32 v44, v44, v40, s35
    v_perm_b32 v121, v45, v41, s34
    v_perm_b32 v45, v45, v41, s35
    v_perm_b32 v122, v46, v42, s34
    v_perm_b32 v46, v46, v42, s35
    v_perm_b32 v123, v47, v43, s34
    v_perm_b32 v47, v47, v43, s35
    v_mov_b32 v40, v120
    v_mov_b32 v41, v121
    v_mov_b32 v42, v122
    v_mov_b32 v43, v123
    v_perm_b32 v120, v52, v48, s34
    v_perm_b32 v52, v52, v48, s35
    v_perm_b32 v121, v53, v49, s34
    v_perm_b32 v53, v53, v49, s35
    v_perm_b32 v122, v54, v50, s34
    v_perm_b32 v54, v54, v50, s35
    v_perm_b32 v123, v55, v51, s34
    v_perm_b32 v55, v55, v51, s35
    v_mov_b32 v48, v120
    v_mov_b32 v49, v121
    v_mov_b32 v50, v122
    v_mov_b32 v51, v123
    v_perm_b32 v120, v60, v56, s34
    v_perm_b32 v60, v60, v56, s35
    v_perm_b32 v121, v61, v57, s34
    v_perm_b32 v61, v61, v57, s35
    v_perm_b32 v122, v62, v58, s34
    v_perm_b32 v62, v62, v58, s35
    v_perm_b32 v123, v63, v59, s34
    v_perm_b32 v63, v63, v59, s35
    v_mov_b32 v56, v120
    v_mov_b32 v57, v121
    v_mov_b32 v58, v122
    v_mov_b32 v59, v123
    v_perm_b32 v120, v68, v64, s34
    v_perm_b32 v68, v68, v64, s35
    v_perm_b32 v121, v69, v65, s34
    v_perm_b32 v69, v69, v65, s35
    v_perm_b32 v122, v70, v66, s34
    v_perm_b32 v70, v70, v66, s35
    v_perm_b32 v123, v71, v67, s34
    v_perm_b32 v71, v71, v67, s35
    v_mov_b32 v64, v120
    v_mov_b32 v65, v121
    v_mov_b32 v66, v122
    v_mov_b32 v67, v123
L_nowo:
    s_cmp_lg_u32 s28, 3
    s_cbranch_scc1 L_nosched
    s_mov_b32 s36, 32
    s_mov_b32 s37, 2
    v_mov_b32 v6, 0
    s_mov_b32 s87, 0
L_ctrwait:
    buffer_load_dword v120, v6, s[24:27], s67 offen sc1
    s_add_u32 s87, s87, 1
    s_waitcnt vmcnt(0)
    v_readfirstlane_b32 s33, v120
    s_nop 0
    s_sub_u32 s33, s33, s68
    s_cmp_lt_u32 s33, 256
    s_cbranch_scc1 L_sched
    s_sleep 8
    s_cmp_lt_u32 s87, 100000
    s_cbranch_scc1 L_ctrwait
L_sched:
    ds_read_b32 v120, v6 offset:4
    s_lshl_b32 s34, s36, 3
    s_waitcnt lgkmcnt(0)
    v_readfirstlane_b32 s33, v120
    s_nop 0
    s_add_u32 s33, s33, 8
    s_cmp_ge_u32 s33, s34
    s_cbranch_scc1 L_grab
    s_sleep 2
    s_add_u32 s87, s87, 1
    s_cmp_lt_u32 s87, 2000000
    s_cbranch_scc1 L_sched
L_grab:
    v_mov_b32 v120, s37
    s_mov_b64 exec, 1
    buffer_atomic_add v120, v6, s[24:27], s67 offen sc0 sc1
    s_mov_b64 exec, -1
    s_waitcnt vmcnt(0)
    v_readfirstlane_b32 s33, v120
    s_nop 0
    s_sub_u32 s33, s33, s68
    s_min_u32 s33, s33, 200
    s_add_u32 s33, s33, 256
    s_add_u32 s34, s33, s37
    s_cmp_gt_u32 s34, 384
    s_cselect_b32 s35, 8, s37
    v_add_u32 v120, s33, v3
    v_add_u32 v121, s36, v3
    v_lshlrev_b32 v121, 2, v121
    v_cmp_gt_u32 vcc, s35, v3
    s_nop 0
    s_and_saveexec_b64 s[38:39], vcc
    ds_write_b32 v121, v120 offset:256
    s_mov_b64 exec, s[38:39]
    s_add_u32 s36, s36, s37
    s_cmp_lt_u32 s33, 336
    s_cselect_b32 s37, 2, 1
    s_cmp_lg_u32 s35, 8
    s_cbranch_scc1 L_sched
L_nosched:
    s_cmp_eq_u32 s64, 0
    s_cbranch_scc1 L_end
    s_lshr_b32 s33, s45, 1
    s_add_u32 s33, s33, 0
    s_and_b32 s35, s45, 1
    s_lshl_b32 s35, s35, 10
    s_cmp_eq_u32 s65, 0
    s_cselect_b32 s33, s33, s45
    s_cselect_b32 s34, s35, 0
    s_cselect_b32 s82, 1, 0
    s_mul_i32 s33, s33, 3
    s_add_u32 s33, s33, s82
    s_lshl_b32 s35, s33, 14
    s_add_u32 s35, s35, s34
    s_add_u32 s80, s35, 524288
    s_lshr_b32 s33, s45, 1
    s_add_u32 s33, s33, 16
    s_and_b32 s35, s45, 1
    s_lshl_b32 s35, s35, 10
    s_cmp_eq_u32 s65, 0
    s_cselect_b32 s33, s33, s45
    s_cselect_b32 s34, s35, 0
    s_cselect_b32 s83, 1, 2
    s_mul_i32 s33, s33, 3
    s_add_u32 s33, s33, s83
    s_lshl_b32 s35, s33, 14
    s_add_u32 s35, s35, s34
    s_add_u32 s81, s35, 524288
    s_cmp_gt_u32 s82, s83
    s_cselect_b32 s44, 1, 0
    s_mov_b32 s46, 0
    v_mov_b32 v6, 0
    v_lshlrev_b32 v4, 2, v3
    v_lshl_add_u32 v4, v2, 8, v4
    v_lshrrev_b32 v5, 3, v3
    v_lshlrev_b32 v5, 5, v5
    v_lshl_add_u32 v5, v2, 8, v5
    v_and_b32 v7, 7, v3
    v_lshlrev_b32 v7, 5, v7
    v_lshrrev_b32 v120, 4, v3
    v_lshl_add_u32 v7, v120, 3, v7
    v_lshl_add_u32 v7, v2, 9, v7
L_combo:
    s_cmp_eq_u32 s44, 0
    s_cselect_b32 s40, s80, s81
    s_cselect_b32 s41, s82, s83
    s_add_u32 s42, s40, 8192
    s_lshl_b32 s47, s41, 7
    s_add_u32 s47, s47, 200
    s_cmp_eq_u32 s41, 2
    s_cselect_b32 s47, -1, s47
    s_mov_b32 s87, 0
L_cwait:
    ds_read_b32 v120, v6 offset:4
    ds_read_b32 v121, v6 offset:16
    s_add_u32 s87, s87, 1
    s_waitcnt lgkmcnt(0)
    v_readfirstlane_b32 s33, v121
    v_readfirstlane_b32 s34, v120
    s_cmp_ge_u32 s33, 1
    s_cbranch_scc1 L_cgo
    s_cmp_ge_u32 s34, s47
    s_cbranch_scc1 L_cgo
    s_sleep 4
    s_cmp_lt_u32 s87, 1000000
    s_cbranch_scc1 L_cwait
L_cgo:
    s_mov_b32 s43, 0
    s_mov_b32 s87, 0
L_round:
    s_bitcmp1_b32 s43, 0
    s_cbranch_scc1 L_skl0
    s_add_u32 s33, s40, 0
    buffer_load_dwordx4 v[72:75], v1, s[24:27], s33 offen sc1
L_skl0:
    s_bitcmp1_b32 s43, 1
    s_cbranch_scc1 L_skl1
    s_add_u32 s33, s40, 2048
    buffer_load_dwordx4 v[76:79], v1, s[24:27], s33 offen sc1
L_skl1:
    s_bitcmp1_b32 s43, 2
    s_cbranch_scc1 L_skl2
    s_add_u32 s33, s40, 4096
    buffer_load_dwordx4 v[80:83], v1, s[24:27], s33 offen sc1
L_skl2:
    s_bitcmp1_b32 s43, 3
    s_cbranch_scc1 L_skl3
    s_add_u32 s33, s40, 6144
    buffer_load_dwordx4 v[84:87], v1, s[24:27], s33 offen sc1
L_skl3:
    s_bitcmp1_b32 s43, 4
    s_cbranch_scc1 L_skl4
    s_add_u32 s33, s40, 8192
    buffer_load_dwordx4 v[88:91], v1, s[24:27], s33 offen sc1
L_skl4:
    s_bitcmp1_b32 s43, 5
    s_cbranch_scc1 L_skl5
    s_add_u32 s33, s40, 10240
    buffer_load_dwordx4 v[92:95], v1, s[24:27], s33 offen sc1
L_skl5:
    s_bitcmp1_b32 s43, 6
    s_cbranch_scc1 L_skl6
    s_add_u32 s33, s40, 12288
    buffer_load_dwordx4 v[96:99], v1, s[24:27], s33 offen sc1
L_skl6:
    s_bitcmp1_b32 s43, 7
    s_cbranch_scc1 L_skl7
    s_add_u32 s33, s40, 14336
    buffer_load_dwordx4 v[100:103], v1, s[24:27], s33 offen sc1
L_skl7:
    s_add_u32 s87, s87, 1
    s_waitcnt vmcnt(0)
    v_cmp_eq_u32 s[48:49], s69, v74
    s_nop 0
    s_cmp_eq_u64 s[48:49], -1
    s_cselect_b32 s33, 1, 0
    s_or_b32 s43, s43, s33
    v_cmp_eq_u32 s[50:51], s69, v78
    s_nop 0
    s_cmp_eq_u64 s[50:51], -1
    s_cselect_b32 s33, 2, 0
    s_or_b32 s43, s43, s33
    v_cmp_eq_u32 s[48:49], s69, v82
    s_nop 0
    s_cmp_eq_u64 s[48:49], -1
    s_cselect_b32 s33, 4, 0
    s_or_b32 s43, s43, s33
    v_cmp_eq_u32 s[50:51], s69, v86
    s_nop 0
    s_cmp_eq_u64 s[50:51], -1
    s_cselect_b32 s33, 8, 0
    s_or_b32 s43, s43, s33
    v_cmp_eq_u32 s[48:49], s69, v90
    s_nop 0
    s_cmp_eq_u64 s[48:49], -1
    s_cselect_b32 s33, 16, 0
    s_or_b32 s43, s43, s33
    v_cmp_eq_u32 s[50:51], s69, v94
    s_nop 0
    s_cmp_eq_u64 s[50:51], -1
    s_cselect_b32 s33, 32, 0
    s_or_b32 s43, s43, s33
    v_cmp_eq_u32 s[48:49], s69, v98
    s_nop 0
    s_cmp_eq_u64 s[48:49], -1
    s_cselect_b32 s33, 64, 0
    s_or_b32 s43, s43, s33
    v_cmp_eq_u32 s[50:51], s69, v102
    s_nop 0
    s_cmp_eq_u64 s[50:51], -1
    s_cselect_b32 s33, 128, 0
    s_or_b32 s43, s43, s33
    s_cmp_eq_u32 s43, 255
    s_cbranch_scc1 L_rdone
    s_cmp_eq_u32 s41, 2
    s_cbranch_scc1 L_rfast
    s_sleep 64
L_rfast:
    s_sleep 1
    s_cmp_lt_u32 s87, 400000
    s_cbranch_scc1 L_round
L_rdone:
    v_max3_f32 v120, v75, v79, v83
    v_max3_f32 v121, v87, v91, v95
    v_max3_f32 v120, v120, v99, v103
    v_max_f32 v120, v120, v121
    v_sub_f32 v74, v75, v120
    v_sub_f32 v78, v79, v120
    v_sub_f32 v82, v83, v120
    v_sub_f32 v86, v87, v120
    v_sub_f32 v90, v91, v120
    v_sub_f32 v94, v95, v120
    v_sub_f32 v98, v99, v120
    v_sub_f32 v102, v103, v120
    v_exp_f32 v74, v74
    v_exp_f32 v78, v78
    v_exp_f32 v82, v82
    v_exp_f32 v86, v86
    v_exp_f32 v90, v90
    v_exp_f32 v94, v94
    v_exp_f32 v98, v98
    v_exp_f32 v102, v102
    v_mov_b32 v120, 0
    v_mov_b32 v122, 0
    v_mov_b32 v123, 0
    v_fmac_f32_dpp v120, v74, v75 quad_perm:[0,0,2,2] row_mask:0xf bank_mask:0xf
    v_fmac_f32_dpp v122, v74, v72 quad_perm:[0,0,2,2] row_mask:0xf bank_mask:0xf
    v_fmac_f32_dpp v123, v74, v73 quad_perm:[0,0,2,2] row_mask:0xf bank_mask:0xf
    v_fmac_f32_dpp v120, v78, v79 quad_perm:[0,0,2,2] row_mask:0xf bank_mask:0xf
    v_fmac_f32_dpp v122, v78, v76 quad_perm:[0,0,2,2] row_mask:0xf bank_mask:0xf
    v_fmac_f32_dpp v123, v78, v77 quad_perm:[0,0,2,2] row_mask:0xf bank_mask:0xf
    v_fmac_f32_dpp v120, v82, v83 quad_perm:[0,0,2,2] row_mask:0xf bank_mask:0xf
    v_fmac_f32_dpp v122, v82, v80 quad_perm:[0,0,2,2] row_mask:0xf bank_mask:0xf
    v_fmac_f32_dpp v123, v82, v81 quad_perm:[0,0,2,2] row_mask:0xf bank_mask:0xf
    v_fmac_f32_dpp v120, v86, v87 quad_perm:[0,0,2,2] row_mask:0xf bank_mask:0xf
    v_fmac_f32_dpp v122, v86, v84 quad_perm:[0,0,2,2] row_mask:0xf bank_mask:0xf
    v_fmac_f32_dpp v123, v86, v85 quad_perm:[0,0,2,2] row_mask:0xf bank_mask:0xf
    v_fmac_f32_dpp v120, v90, v91 quad_perm:[0,0,2,2] row_mask:0xf bank_mask:0xf
    v_fmac_f32_dpp v122, v90, v88 quad_perm:[0,0,2,2] row_mask:0xf bank_mask:0xf
    v_fmac_f32_dpp v123, v90, v89 quad_perm:[0,0,2,2] row_mask:0xf bank_mask:0xf
    v_fmac_f32_dpp v120, v94, v95 quad_perm:[0,0,2,2] row_mask:0xf bank_mask:0xf
    v_fmac_f32_dpp v122, v94, v92 quad_perm:[0,0,2,2] row_mask:0xf bank_mask:0xf
    v_fmac_f32_dpp v123, v94, v93 quad_perm:[0,0,2,2] row_mask:0xf bank_mask:0xf
    v_fmac_f32_dpp v120, v98, v99 quad_perm:[0,0,2,2] row_mask:0xf bank_mask:0xf
    v_fmac_f32_dpp v122, v98, v96 quad_perm:[0,0,2,2] row_mask:0xf bank_mask:0xf
    v_fmac_f32_dpp v123, v98, v97 quad_perm:[0,0,2,2] row_mask:0xf bank_mask:0xf
    v_fmac_f32_dpp v120, v102, v103 quad_perm:[0,0,2,2] row_mask:0xf bank_mask:0xf
    v_fmac_f32_dpp v122, v102, v100 quad_perm:[0,0,2,2] row_mask:0xf bank_mask:0xf
    v_fmac_f32_dpp v123, v102, v101 quad_perm:[0,0,2,2] row_mask:0xf bank_mask:0xf
    v_rcp_f32 v120, v120
    s_nop 1
    v_mul_f32_dpp v122, v120, v122 quad_perm:[1,1,3,3] row_mask:0xf bank_mask:0xf
    v_mul_f32_dpp v123, v120, v123 quad_perm:[1,1,3,3] row_mask:0xf bank_mask:0xf
    v_cvt_pk_bf16_f32 v120, v122, v123
    ds_write_b32 v4, v120 offset:6912
    ds_read_b128 v[112:115], v5 offset:6912
    ds_read_b128 v[116:119], v5 offset:6928
    s_lshl_b32 s33, s44, 8
    v_add_u32 v120, s33, v7
    s_waitcnt lgkmcnt(0)
    v_dot2_f32_bf16 v104, v8, v112, 0
    v_dot2_f32_bf16 v105, v12, v112, 0
    v_dot2_f32_bf16 v106, v9, v112, 0
    v_dot2_f32_bf16 v107, v13, v112, 0
    v_dot2_f32_bf16 v108, v10, v112, 0
    v_dot2_f32_bf16 v109, v14, v112, 0
    v_dot2_f32_bf16 v110, v11, v112, 0
    v_dot2_f32_bf16 v111, v15, v112, 0
    v_dot2_f32_bf16 v104, v16, v113, v104
    v_dot2_f32_bf16 v105, v20, v113, v105
    v_dot2_f32_bf16 v106, v17, v113, v106
    v_dot2_f32_bf16 v107, v21, v113, v107
    v_dot2_f32_bf16 v108, v18, v113, v108
    v_dot2_f32_bf16 v109, v22, v113, v109
    v_dot2_f32_bf16 v110, v19, v113, v110
    v_dot2_f32_bf16 v111, v23, v113, v111
    v_dot2_f32_bf16 v104, v24, v114, v104
    v_dot2_f32_bf16 v105, v28, v114, v105
    v_dot2_f32_bf16 v106, v25, v114, v106
    v_dot2_f32_bf16 v107, v29, v114, v107
    v_dot2_f32_bf16 v108, v26, v114, v108
    v_dot2_f32_bf16 v109, v30, v114, v109
    v_dot2_f32_bf16 v110, v27, v114, v110
    v_dot2_f32_bf16 v111, v31, v114, v111
    v_dot2_f32_bf16 v104, v32, v115, v104
    v_dot2_f32_bf16 v105, v36, v115, v105
    v_dot2_f32_bf16 v106, v33, v115, v106
    v_dot2_f32_bf16 v107, v37, v115, v107
    v_dot2_f32_bf16 v108, v34, v115, v108
    v_dot2_f32_bf16 v109, v38, v115, v109
    v_dot2_f32_bf16 v110, v35, v115, v110
    v_dot2_f32_bf16 v111, v39, v115, v111
    v_dot2_f32_bf16 v104, v40, v116, v104
    v_dot2_f32_bf16 v105, v44, v116, v105
    v_dot2_f32_bf16 v106, v41, v116, v106
    v_dot2_f32_bf16 v107, v45, v116, v107
    v_dot2_f32_bf16 v108, v42, v116, v108
    v_dot2_f32_bf16 v109, v46, v116, v109
    v_dot2_f32_bf16 v110, v43, v116, v110
    v_dot2_f32_bf16 v111, v47, v116, v111
    v_dot2_f32_bf16 v104, v48, v117, v104
    v_dot2_f32_bf16 v105, v52, v117, v105
    v_dot2_f32_bf16 v106, v49, v117, v106
    v_dot2_f32_bf16 v107, v53, v117, v107
    v_dot2_f32_bf16 v108, v50, v117, v108
    v_dot2_f32_bf16 v109, v54, v117, v109
    v_dot2_f32_bf16 v110, v51, v117, v110
    v_dot2_f32_bf16 v111, v55, v117, v111
    v_dot2_f32_bf16 v104, v56, v118, v104
    v_dot2_f32_bf16 v105, v60, v118, v105
    v_dot2_f32_bf16 v106, v57, v118, v106
    v_dot2_f32_bf16 v107, v61, v118, v107
    v_dot2_f32_bf16 v108, v58, v118, v108
    v_dot2_f32_bf16 v109, v62, v118, v109
    v_dot2_f32_bf16 v110, v59, v118, v110
    v_dot2_f32_bf16 v111, v63, v118, v111
    v_dot2_f32_bf16 v104, v64, v119, v104
    v_dot2_f32_bf16 v105, v68, v119, v105
    v_dot2_f32_bf16 v106, v65, v119, v106
    v_dot2_f32_bf16 v107, v69, v119, v107
    v_dot2_f32_bf16 v108, v66, v119, v108
    v_dot2_f32_bf16 v109, v70, v119, v109
    v_dot2_f32_bf16 v110, v67, v119, v110
    v_dot2_f32_bf16 v111, v71, v119, v111
    v_permlane32_swap_b32 v104, v108
    v_permlane32_swap_b32 v105, v109
    v_permlane32_swap_b32 v106, v110
    v_permlane32_swap_b32 v107, v111
    v_add_f32 v104, v104, v108
    v_add_f32 v105, v105, v109
    v_add_f32 v106, v106, v110
    v_add_f32 v107, v107, v111
    s_nop 0
    v_permlane16_swap_b32 v104, v106
    v_permlane16_swap_b32 v105, v107
    v_add_f32 v104, v104, v106
    v_add_f32 v105, v105, v107
    s_nop 0
    v_add_f32_dpp v104, v104, v104 row_ror:8 row_mask:0xf bank_mask:0xf
    v_add_f32_dpp v105, v105, v105 row_ror:8 row_mask:0xf bank_mask:0xf
    ds_write_b64 v120, v[104:105] offset:4864
    s_xor_b32 s44, s44, 1
    s_add_u32 s46, s46, 1
    s_cmp_lt_u32 s46, 2
    s_cbranch_scc1 L_combo
    v_mov_b32 v121, 1
    v_lshlrev_b32 v122, 3, v3
    s_mov_b64 exec, 1
    ds_add_rtn_u32 v120, v6, v121 offset:28
    s_mov_b64 exec, -1
    ds_read_b64 v[8:9], v122 offset:4864
    ds_read_b64 v[10:11], v122 offset:5376
    ds_read_b64 v[12:13], v122 offset:5888
    ds_read_b64 v[14:15], v122 offset:6400
    s_lshl_b32 s32, s78, 10
    s_add_u32 s32, s32, s79
    v_mov_b32 v42, s69
    v_mov_b32 v43, s69
    s_mov_b32 s60, s8
    s_and_b32 s61, s9, 0xffff
    s_mov_b32 s62, 0x1200
    s_mov_b32 s63, 0x20000
    s_waitcnt lgkmcnt(0)
    v_readfirstlane_b32 s33, v120
    s_nop 0
    s_cmp_lg_u32 s33, 3
    s_cbranch_scc1 L_end
    v_pk_add_f32 v[8:9], v[8:9], v[10:11]
    v_pk_add_f32 v[12:13], v[12:13], v[14:15]
    v_pk_add_f32 v[40:41], v[8:9], v[12:13]
    buffer_store_dwordx4 v[40:43], v1, s[24:27], s32 offen sc1
    s_cmp_lg_u32 s78, 0
    s_cbranch_scc1 L_end
    v_lshrrev_b32 v5, 5, v3
    v_mul_u32_u24 v5, 2304, v5
    v_and_b32 v6, 31, v3
    v_lshl_add_u32 v5, v6, 2, v5
    s_mul_i32 s32, s65, 1152
    s_add_u32 s32, s32, s66
    s_add_u32 s34, s79, 4096
    s_mov_b32 s33, 0
    s_mov_b32 s43, 1
L_polly:
    s_bitcmp1_b32 s43, 1
    s_cbranch_scc1 L_sky1
    buffer_load_dwordx4 v[12:15], v1, s[24:27], s79 offen offset:1024 sc1
L_sky1:
    s_bitcmp1_b32 s43, 2
    s_cbranch_scc1 L_sky2
    buffer_load_dwordx4 v[16:19], v1, s[24:27], s79 offen offset:2048 sc1
L_sky2:
    s_bitcmp1_b32 s43, 3
    s_cbranch_scc1 L_sky3
    buffer_load_dwordx4 v[20:23], v1, s[24:27], s79 offen offset:3072 sc1
L_sky3:
    s_bitcmp1_b32 s43, 4
    s_cbranch_scc1 L_sky4
    buffer_load_dwordx4 v[24:27], v1, s[24:27], s34 offen offset:0 sc1
L_sky4:
    s_bitcmp1_b32 s43, 5
    s_cbranch_scc1 L_sky5
    buffer_load_dwordx4 v[28:31], v1, s[24:27], s34 offen offset:1024 sc1
L_sky5:
    s_bitcmp1_b32 s43, 6
    s_cbranch_scc1 L_sky6
    buffer_load_dwordx4 v[32:35], v1, s[24:27], s34 offen offset:2048 sc1
L_sky6:
    s_bitcmp1_b32 s43, 7
    s_cbranch_scc1 L_sky7
    buffer_load_dwordx4 v[36:39], v1, s[24:27], s34 offen offset:3072 sc1
L_sky7:
    s_add_u32 s33, s33, 1
    s_waitcnt vmcnt(0)
    v_cmp_eq_u32 s[50:51], s69, v14
    s_nop 0
    s_cmp_eq_u64 s[50:51], -1
    s_cselect_b32 s35, 2, 0
    s_or_b32 s43, s43, s35
    v_cmp_eq_u32 s[48:49], s69, v18
    s_nop 0
    s_cmp_eq_u64 s[48:49], -1
    s_cselect_b32 s35, 4, 0
    s_or_b32 s43, s43, s35
    v_cmp_eq_u32 s[50:51], s69, v22
    s_nop 0
    s_cmp_eq_u64 s[50:51], -1
    s_cselect_b32 s35, 8, 0
    s_or_b32 s43, s43, s35
    v_cmp_eq_u32 s[48:49], s69, v26
    s_nop 0
    s_cmp_eq_u64 s[48:49], -1
    s_cselect_b32 s35, 16, 0
    s_or_b32 s43, s43, s35
    v_cmp_eq_u32 s[50:51], s69, v30
    s_nop 0
    s_cmp_eq_u64 s[50:51], -1
    s_cselect_b32 s35, 32, 0
    s_or_b32 s43, s43, s35
    v_cmp_eq_u32 s[48:49], s69, v34
    s_nop 0
    s_cmp_eq_u64 s[48:49], -1
    s_cselect_b32 s35, 64, 0
    s_or_b32 s43, s43, s35
    v_cmp_eq_u32 s[50:51], s69, v38
    s_nop 0
    s_cmp_eq_u64 s[50:51], -1
    s_cselect_b32 s35, 128, 0
    s_or_b32 s43, s43, s35
    s_cmp_eq_u32 s43, 255
    s_cbranch_scc1 L_polly_done
    s_cmp_lt_u32 s33, 400000
    s_cbranch_scc1 L_polly
L_polly_done:
    v_pk_add_f32 v[12:13], v[12:13], v[16:17]
    v_pk_add_f32 v[20:21], v[20:21], v[24:25]
    v_pk_add_f32 v[28:29], v[28:29], v[32:33]
    v_pk_add_f32 v[36:37], v[36:37], v[40:41]
    v_pk_add_f32 v[12:13], v[12:13], v[20:21]
    v_pk_add_f32 v[28:29], v[28:29], v[36:37]
    v_pk_add_f32 v[12:13], v[12:13], v[28:29]
    v_cvt_pk_bf16_f32 v8, v12, v13
    buffer_store_dword v8, v5, s[60:63], s32 offen
L_end:
    s_endpgm
.section .rodata,"a"
.p2align 6
.amdhsa_kernel concat_heads__gqa_block_cached__mha_block_cached__decode_kernel
  .amdhsa_next_free_vgpr 128
  .amdhsa_next_free_sgpr 98
  .amdhsa_accum_offset 128
  .amdhsa_group_segment_fixed_size 0
  .amdhsa_kernarg_size 104
  .amdhsa_user_sgpr_count 2
  .amdhsa_user_sgpr_kernarg_segment_ptr 1
  .amdhsa_system_sgpr_workgroup_id_x 1
.end_amdhsa_kernel
```
